```python
import torch

def _softmax(x, axis=-1):
    return torch.softmax(x, dim=axis)
def _gelu(x):
    return torch.nn.functional.gelu(x, approximate="tanh")
def _silu(x):
    return torch.nn.functional.silu(x)
def _sigmoid(x):
    return torch.sigmoid(x)
def _layernorm(x, axis=-1, eps=1e-5):
    m = x.mean(dim=axis, keepdim=True)
    v = x.var(dim=axis, keepdim=True, unbiased=False)
    return (x - m) / torch.sqrt(v + eps)
def _scatter_add(tgt, idx, src, axis=0):
    return tgt.clone().index_add_(axis, idx, src)
def _segment_sum(src, seg, n):
    out = torch.zeros((n,) + src.shape[1:], dtype=src.dtype)
    return out.index_add_(0, seg, src)
def _pad(x, pw):
    flat = tuple(v for pair in reversed(pw) for v in pair)
    return torch.nn.functional.pad(x, flat)

kernel_name = 'concat_heads__mha_block_cached__gqa_block_cached__near_ridge'

def setup_inputs():

    _w = (lambda a: (lambda t: t.to(torch.bfloat16) if t.is_floating_point() else t)(torch.as_tensor(a)))
    def _A_setup():
        B, Sq, D = 32, 48, 448
        H, Sk, Dh = 16, 48, 256
        return {
            "x": _w((lambda *s: torch.randn(*s, dtype=torch.bfloat16) * 0.8)(B, Sq, D)),
            "k_cache": _w((lambda *s: torch.randn(*s, dtype=torch.bfloat16) * 0.8)(B, H, Sk, Dh)),
            "v_cache": _w((lambda *s: torch.randn(*s, dtype=torch.bfloat16) * 0.05)(B, H, Sk, Dh)),
            "wq": _w((lambda *s: torch.randn(*s, dtype=torch.bfloat16) * 0.8)(D, H * Dh) * (D ** -0.5)),
            "wo": _w((lambda *s: torch.randn(*s, dtype=torch.bfloat16) * 0.05)(H * Dh, D) * ((H * Dh) ** -0.5)),
        }
    _A_in = _A_setup()

    def _B_setup():
        B, Sq, D = 32, 48, 448
        Hq, Hkv, Sk, Dh = 16, 16, 48, 256
        assert Hq % Hkv == 0, (Hq, Hkv)
        return {
            "x": _w((lambda *s: torch.randn(*s, dtype=torch.bfloat16) * 0.8)(B, Sq, D)),
            "k_cache": _w((lambda *s: torch.randn(*s, dtype=torch.bfloat16) * 0.8)(B, Hkv, Sk, Dh)),
            "v_cache": _w((lambda *s: torch.randn(*s, dtype=torch.bfloat16) * 0.05)(B, Hkv, Sk, Dh)),
            "wq": _w((lambda *s: torch.randn(*s, dtype=torch.bfloat16) * 0.8)(D, Hq * Dh) * (D ** -0.5)),
            "wo": _w((lambda *s: torch.randn(*s, dtype=torch.bfloat16) * 0.05)(Hq * Dh, D) * ((Hq * Dh) ** -0.5)),
        }
    _B_in = _B_setup()

    return {
        "A_x": _A_in["x"],
        "A_k_cache": _A_in["k_cache"],
        "A_v_cache": _A_in["v_cache"],
        "A_wq": _A_in["wq"],
        "A_wo": _A_in["wo"],
        "B_x": _B_in["x"],
        "B_k_cache": _B_in["k_cache"],
        "B_v_cache": _B_in["v_cache"],
        "B_wq": _B_in["wq"],
        "B_wo": _B_in["wo"],
    }

def reference(A_x, A_k_cache, A_v_cache, A_wq, A_wo, B_x, B_k_cache, B_v_cache, B_wq, B_wo):
    def _A_ref(x, k_cache, v_cache, wq, wo):
        B, Sq, D = x.shape
        H, Dh = 16, 256
        q = (lambda x, *d: x.permute(*d))((x @ wq).reshape(B, Sq, H, Dh), 0, 2, 1, 3)
        scores = torch.einsum("bhqd,bhkd->bhqk", q, k_cache) * (Dh ** -0.5)
        p = _softmax(scores, axis=-1)
        o = torch.einsum("bhqk,bhkd->bhqd", p, v_cache)
        return (lambda x, *d: x.permute(*d))(o, 0, 2, 1, 3).reshape(B, Sq, H * Dh) @ wo

    def _B_ref(x, k_cache, v_cache, wq, wo):
        B, Sq, D = x.shape
        Hq, Dh = 16, 256
        Hkv = k_cache.shape[1]
        rep = Hq // Hkv
        q = (lambda x, *d: x.permute(*d))((x @ wq).reshape(B, Sq, Hq, Dh), 0, 2, 1, 3)
        k = (lambda x, n, axis: torch.repeat_interleave(x, n, dim=axis))(k_cache, rep, axis=1)
        v = (lambda x, n, axis: torch.repeat_interleave(x, n, dim=axis))(v_cache, rep, axis=1)
        scores = torch.einsum("bhqd,bhkd->bhqk", q, k) * (Dh ** -0.5)
        p = _softmax(scores, axis=-1)
        o = torch.einsum("bhqk,bhkd->bhqd", p, v)
        return (lambda x, *d: x.permute(*d))(o, 0, 2, 1, 3).reshape(B, Sq, Hq * Dh) @ wo

    a = _A_ref(A_x, A_k_cache, A_v_cache, A_wq, A_wo)
    b = _B_ref(B_x, B_k_cache, B_v_cache, B_wq, B_wo)
    return torch.concatenate([a, b], axis=-1)
```

```asm
; @launch grid=(256,1,1) block=(256,1,1) lds=163840
.amdgcn_target "amdgcn-amd-amdhsa--gfx950"
.text
.globl concat_heads__mha_block_cached__gqa_block_cached__near_ridge_kernel
.p2align 8
.type concat_heads__mha_block_cached__gqa_block_cached__near_ridge_kernel,@function
concat_heads__mha_block_cached__gqa_block_cached__near_ridge_kernel:
    s_cmp_ge_u32 s2, 256
    s_cbranch_scc1 L_main_end
    s_getpc_b64 s[60:61]
L_pc0:
    s_lshr_b32 s54, s2, 3
    s_lshl_b32 s54, s54, 12
    v_lshl_add_u32 v2, v0, 4, s54
    v_min_u32 v2, (L_main_end-L_pc0)/16*16-16, v2
    global_load_dword v245, v2, s[60:61]
    s_load_dwordx8 s[64:71], s[0:1], 0
    s_load_dwordx2 s[72:73], s[0:1], 32
    s_load_dwordx8 s[76:83], s[0:1], 40
    s_load_dwordx2 s[74:75], s[0:1], 72
    s_load_dwordx4 s[84:87], s[0:1], 80
    s_load_dwordx2 s[4:5], s[0:1], 96
    s_getpc_b64 s[60:61]
L_pc:
    v_lshrrev_b32 v2, 6, v0
    v_and_b32 v1, 63, v0
    v_readfirstlane_b32 s32, v2
    s_and_b32 s54, s2, 7
    s_lshr_b32 s55, s2, 3
    s_lshr_b32 s35, s54, 2
    s_and_b32 s88, s54, 3
    s_lshl_b32 s54, s88, 2
    s_and_b32 s89, s55, 1
    s_lshl_b32 s56, s89, 1
    s_add_u32 s36, s54, s56
    s_lshr_b32 s37, s55, 1
    s_and_b32 s94, s37, 0
    s_lshl_b32 s37, s37, 1
    s_lshl_b32 s90, s55, 2
    s_add_u32 s90, s90, s32
    s_and_b32 s33, s32, 1
    s_lshr_b32 s34, s32, 1
    s_add_u32 s38, s37, s33
    s_lshl_b32 s50, s32, 13
    s_lshl_b32 s51, s32, 10
    s_add_u32 s51, s51, 98304
    s_mov_b32 s41, s51
    s_lshl_b32 s39, s36, 9
    s_mul_i32 s40, s37, 43008
    s_lshl_b32 s54, s33, 4
    s_lshl_b32 s55, s34, 2
    s_add_u32 s54, s54, s55
    s_lshl_b32 s54, s54, 13
    v_lshlrev_b32 v241, 4, v1
    v_add_u32 v3, s54, v241
    v_xor_b32 v2, 0, v3
    v_add_u32 v208, 0, v2
    v_xor_b32 v2, 32, v3
    v_add_u32 v209, 7168, v2
    v_xor_b32 v2, 64, v3
    v_add_u32 v210, 14336, v2
    v_xor_b32 v2, 96, v3
    v_add_u32 v211, 21504, v2
    v_xor_b32 v2, 128, v3
    v_add_u32 v212, 65536, v2
    v_xor_b32 v2, 160, v3
    v_add_u32 v213, 72704, v2
    v_xor_b32 v2, 192, v3
    v_add_u32 v214, 79872, v2
    v_xor_b32 v2, 224, v3
    v_add_u32 v215, 87040, v2
    v_lshrrev_b32 v2, 3, v1
    v_mul_u32_u24 v2, 896, v2
    v_lshrrev_b32 v3, 4, v1
    s_lshl_b32 s54, s33, 2
    v_add_u32 v3, s54, v3
    v_and_b32 v4, 7, v1
    v_xor_b32 v3, v3, v4
    v_lshl_add_u32 v2, v3, 4, v2
    s_mul_i32 s54, s32, 7168
    v_add_u32 v218, s54, v2
    v_and_b32 v2, 15, v1
    v_lshrrev_b32 v3, 4, v1
    v_mov_b32 v7, 2147479552
    v_lshlrev_b32 v4, 7, v2
    v_cmp_gt_u32 vcc, 16, v1
    s_lshl_b32 s63, s90, 13
    s_lshl_b32 s54, s88, 11
    v_cndmask_b32 v9, v7, v4, vcc
    s_add_u32 s63, s63, s54
    v_lshl_add_u32 v4, v3, 20, v4
    v_cmp_gt_u32 vcc, 32, v1
    s_lshl_b32 s54, s89, 2
    s_add_u32 s54, s54, s32
    v_cndmask_b32 v224, v7, v4, vcc
    s_mul_i32 s55, s54, 24
    s_mul_i32 s56, s54, 36
    v_add_u32 v4, s55, v1
    v_lshrrev_b32 v5, 1, v4
    v_mul_u32_u24 v5, 896, v5
    v_and_b32 v4, 1, v4
    v_lshl_add_u32 v4, v4, 7, v5
    v_cmp_gt_u32 vcc, 24, v1
    v_add_u32 v5, s56, v1
    v_mul_u32_u24 v6, 21846, v5
    v_cndmask_b32 v225, v7, v4, vcc
    v_lshrrev_b32 v6, 16, v6
    v_mul_u32_u24 v4, 3, v6
    v_sub_u32 v5, v5, v4
    v_mul_u32_u24 v6, 896, v6
    v_lshl_add_u32 v5, v5, 7, v6
    v_cmp_gt_u32 vcc, 36, v1
    s_nop 1
    s_nop 0
    v_cndmask_b32 v226, v7, v5, vcc
    s_waitcnt lgkmcnt(0)
    s_cmp_eq_u32 s35, 0
    s_cselect_b64 s[64:65], s[64:65], s[76:77]
    s_cselect_b64 s[70:71], s[70:71], s[82:83]
    s_cselect_b64 s[66:67], s[66:67], s[78:79]
    s_cselect_b64 s[68:69], s[68:69], s[80:81]
    s_cselect_b64 s[72:73], s[72:73], s[74:75]
    s_mov_b32 s8, s64
    s_and_b32 s9, s65, 0xffff
    s_mov_b32 s10, 1376256
    s_mov_b32 s11, 0x20000
    s_mov_b32 s20, s70
    s_and_b32 s21, s71, 0xffff
    s_mov_b32 s22, 3670016
    s_mov_b32 s23, 0x20000
    s_add_u32 s44, s40, 0
    s_add_u32 m0, s41, 0
    s_nop 0
    buffer_load_dwordx4 v218, s[8:11], s44 offen nt lds
    s_add_u32 s44, s40, 28672
    s_add_u32 m0, s41, 4096
    s_nop 0
    buffer_load_dwordx4 v218, s[8:11], s44 offen nt lds
    s_add_u32 s44, s40, 57344
    s_add_u32 m0, s41, 8192
    s_nop 0
    buffer_load_dwordx4 v218, s[8:11], s44 offen nt lds
    s_add_u32 s46, s39, 0
    s_add_u32 m0, s50, 0
    s_nop 0
    buffer_load_dwordx4 v208, s[20:23], s46 offen offset:0 lds
    buffer_load_dwordx4 v209, s[20:23], s46 offen offset:1024 lds
    buffer_load_dwordx4 v210, s[20:23], s46 offen offset:2048 lds
    buffer_load_dwordx4 v211, s[20:23], s46 offen offset:3072 lds
    s_add_u32 m0, s50, 4096
    s_nop 0
    buffer_load_dwordx4 v212, s[20:23], s46 offen offset:0 lds
    buffer_load_dwordx4 v213, s[20:23], s46 offen offset:1024 lds
    buffer_load_dwordx4 v214, s[20:23], s46 offen offset:2048 lds
    buffer_load_dwordx4 v215, s[20:23], s46 offen offset:3072 lds
    s_add_u32 s55, s63, 0
    buffer_load_dword v245, v9, s[20:23], s55 offen
    s_add_u32 s44, s40, 128
    s_add_u32 m0, s41, 12288
    s_nop 0
    buffer_load_dwordx4 v218, s[8:11], s44 offen nt lds
    s_add_u32 s44, s40, 28800
    s_add_u32 m0, s41, 16384
    s_nop 0
    buffer_load_dwordx4 v218, s[8:11], s44 offen nt lds
    s_add_u32 s44, s40, 57472
    s_add_u32 m0, s41, 20480
    s_nop 0
    buffer_load_dwordx4 v218, s[8:11], s44 offen nt lds
    v_mov_b32 v227, v9
    v_lshrrev_b32 v4, 1, v2
    v_xor_b32 v4, v4, v3
    v_lshlrev_b32 v4, 4, v4
    v_lshl_add_u32 v4, v2, 7, v4
    s_mul_i32 s54, s33, 6144
    s_add_u32 s54, s54, 98304
    v_add_u32 v216, s54, v4
    v_xor_b32 v217, 64, v216
    v_lshlrev_b32 v4, 7, v1
    v_cmp_gt_u32 vcc, 32, v1
    s_mov_b32 s12, s66
    s_and_b32 s13, s67, 0xffff
    s_mov_b32 s14, 12582912
    s_mov_b32 s15, 0x20000
    v_cndmask_b32 v244, v7, v4, vcc
    s_mov_b32 s16, s68
    s_and_b32 s17, s69, 0xffff
    s_mov_b32 s18, 12582912
    s_mov_b32 s19, 0x20000
    s_mov_b32 s24, s72
    s_and_b32 s25, s73, 0xffff
    s_mov_b32 s26, 3670016
    s_mov_b32 s27, 0x20000
    s_mov_b32 s28, s4
    s_and_b32 s29, s5, 0xffff
    s_mov_b32 s30, 22020096
    s_mov_b32 s31, 0x20000
    v_lshrrev_b32 v10, 2, v1
    v_and_b32 v11, 7, v10
    v_and_b32 v12, 3, v1
    v_lshlrev_b32 v12, 3, v12
    s_lshl_b32 s54, s34, 9
    v_lshl_add_u32 v5, v10, 10, v12
    v_add_u32 v5, s54, v5
    v_xor_b32 v6, 0, v11
    v_lshl_add_u32 v192, v6, 5, v5
    v_add_u32 v200, 0x10000, v192
    v_xor_b32 v6, 1, v11
    v_lshl_add_u32 v193, v6, 5, v5
    v_add_u32 v201, 0x10000, v193
    v_xor_b32 v6, 2, v11
    v_lshl_add_u32 v194, v6, 5, v5
    v_add_u32 v202, 0x10000, v194
    v_xor_b32 v6, 3, v11
    v_lshl_add_u32 v195, v6, 5, v5
    v_add_u32 v203, 0x10000, v195
    v_xor_b32 v6, 4, v11
    v_lshl_add_u32 v196, v6, 5, v5
    v_add_u32 v204, 0x10000, v196
    v_xor_b32 v6, 5, v11
    v_lshl_add_u32 v197, v6, 5, v5
    v_add_u32 v205, 0x10000, v197
    v_xor_b32 v6, 6, v11
    v_lshl_add_u32 v198, v6, 5, v5
    v_add_u32 v206, 0x10000, v198
    v_xor_b32 v6, 7, v11
    v_lshl_add_u32 v199, v6, 5, v5
    v_add_u32 v207, 0x10000, v199
    s_lshl_b32 s54, s38, 4
    s_add_u32 s54, s54, s36
    s_add_u32 s54, s54, s34
    s_mul_i32 s42, s54, 24576
    s_mul_i32 s43, s32, 8320
    s_add_u32 s43, s43, 130560
    v_lshlrev_b32 v4, 2, v3
    v_xor_b32 v4, v4, v2
    v_lshlrev_b32 v4, 4, v4
    v_lshl_add_u32 v223, v3, 9, v4
    v_lshrrev_b32 v4, 2, v2
    v_mul_u32_u24 v4, 1040, v4
    v_and_b32 v5, 3, v2
    v_lshl_add_u32 v4, v5, 8, v4
    v_lshl_add_u32 v4, v3, 3, v4
    v_add_u32 v4, s43, v4
    v_xor_b32 v6, 0, v5
    v_lshl_add_u32 v219, v6, 6, v4
    v_xor_b32 v6, 1, v5
    v_lshl_add_u32 v220, v6, 6, v4
    v_xor_b32 v6, 2, v5
    v_lshl_add_u32 v221, v6, 6, v4
    v_xor_b32 v6, 3, v5
    v_lshl_add_u32 v222, v6, 6, v4
    s_mul_i32 s59, s36, 229376
    s_lshl_b32 s54, s37, 4
    s_add_u32 s54, s54, s36
    s_mul_i32 s58, s54, 24576
    s_mul_i32 s54, s34, 393216
    s_mul_i32 s55, s33, 12288
    s_add_u32 s62, s58, s54
    s_add_u32 s62, s62, s55
    s_add_u32 s54, s36, s35
    s_lshl_b32 s54, s54, 5
    s_add_u32 s54, s54, s38
    s_mul_i32 s52, s54, 43008
    s_mul_i32 s54, s34, 3072
    s_add_u32 s52, s52, s54
    s_mov_b32 s53, 0x3db8aa3b
    s_lshr_b32 s54, s90, 6
    s_lshl_b32 s55, s88, 1
    s_add_u32 s54, s54, s55
    s_mul_i32 s91, s54, 458752
    s_and_b32 s54, s90, 63
    s_mul_i32 s54, s54, 3584
    s_add_u32 s91, s91, s54
    s_mul_i32 s54, s33, 24576
    s_add_u32 s54, s54, 98304
    v_xor_b32 v5, v3, v2
    v_lshlrev_b32 v5, 4, v5
    v_lshl_add_u32 v5, v2, 8, v5
    v_add_u32 v233, s54, v5
    v_xor_b32 v234, 64, v233
    v_xor_b32 v235, 128, v233
    v_xor_b32 v236, 192, v233
    s_lshl_b32 s54, s32, 2
    v_add_u32 v5, s54, v3
    v_xor_b32 v5, v5, v2
    v_lshlrev_b32 v5, 4, v5
    v_lshl_add_u32 v5, v3, 9, v5
    s_lshl_b32 s54, s32, 11
    v_add_u32 v232, s54, v5
    v_lshl_add_u32 v5, v10, 7, v12
    v_bfe_u32 v4, v1, 3, 2
    s_lshl_b32 s54, s34, 1
    s_add_u32 s57, s54, 0
    v_xor_b32 v6, s57, v4
    v_lshl_add_u32 v237, v6, 5, v5
    v_add_u32 v239, 0x10000, v237
    s_add_u32 s57, s54, 1
    v_xor_b32 v6, s57, v4
    v_lshl_add_u32 v238, v6, 5, v5
    v_add_u32 v240, 0x10000, v238
    v_lshrrev_b32 v5, 5, v1
    v_lshl_add_u32 v4, v5, 3, v4
    v_mul_u32_u24 v4, 896, v4
    v_lshlrev_b32 v5, 1, v3
    v_and_b32 v6, 7, v1
    v_xor_b32 v5, v5, v6
    v_lshl_add_u32 v4, v5, 4, v4
    s_mul_i32 s54, s32, 57344
    v_add_u32 v228, s54, v4
    v_add_u32 v229, 13312, v228
    v_add_u32 v230, 1536, v228
    v_add_u32 v231, 14848, v228
    s_mul_i32 s54, s33, 3072
    s_add_u32 s54, s54, 147456
    v_add_u32 v242, s54, v241
    s_mul_i32 s55, s33, 1536
    s_add_u32 s55, s55, 159744
    v_lshl_add_u32 v243, v1, 3, s55
    s_mul_i32 s3, s34, 6144
    s_cmp_eq_u32 s34, 0
    s_cselect_b64 s[100:101], -1, 0
    s_sub_u32 s54, s54, s55
    s_cmp_eq_u32 s34, 0
    s_cselect_b32 s61, s54, 0
    s_add_u32 s46, s39, 262144
    s_add_u32 m0, s50, 32768
    s_nop 0
    buffer_load_dwordx4 v208, s[20:23], s46 offen offset:0 lds
    buffer_load_dwordx4 v209, s[20:23], s46 offen offset:1024 lds
    buffer_load_dwordx4 v210, s[20:23], s46 offen offset:2048 lds
    buffer_load_dwordx4 v211, s[20:23], s46 offen offset:3072 lds
    s_add_u32 m0, s50, 36864
    s_nop 0
    buffer_load_dwordx4 v212, s[20:23], s46 offen offset:0 lds
    buffer_load_dwordx4 v213, s[20:23], s46 offen offset:1024 lds
    buffer_load_dwordx4 v214, s[20:23], s46 offen offset:2048 lds
    buffer_load_dwordx4 v215, s[20:23], s46 offen offset:3072 lds
    s_mov_b32 s4, s4
    s_and_b32 s5, s5, 0xffff
    s_mov_b32 s6, 22028288
    s_mov_b32 s7, 0x20000
    s_mov_b32 s76, s84
    s_and_b32 s77, s85, 0xffff
    s_mov_b32 s78, 2752512
    s_mov_b32 s79, 0x20000
    s_mov_b32 s80, s86
    s_and_b32 s81, s87, 0xffff
    s_mov_b32 s82, 256
    s_mov_b32 s83, 0x20000
    v_mov_b32 v253, 0
    s_lshl_b32 s54, s35, 5
    s_add_u32 s54, s54, s37
    s_lshl_b32 s95, s54, 7
    s_add_u32 s95, s95, 22020096
    s_waitcnt vmcnt(12)
    s_barrier
    ds_read_b128 a[136:139], v216 offset:0
    ds_read_b128 a[140:143], v216 offset:2048
    ds_read_b128 a[144:147], v216 offset:4096
    ds_read_b128 a[148:151], v217 offset:0
    ds_read_b128 a[152:155], v217 offset:2048
    ds_read_b128 a[156:159], v217 offset:4096
    ds_read_b64_tr_b16 a[0:1], v192 offset:0
    ds_read_b64_tr_b16 a[2:3], v192 offset:16384
    ds_read_b64_tr_b16 a[4:5], v193 offset:0
    ds_read_b64_tr_b16 a[6:7], v193 offset:16384
    ds_read_b64_tr_b16 a[8:9], v194 offset:0
    ds_read_b64_tr_b16 a[10:11], v194 offset:16384
    ds_read_b64_tr_b16 a[12:13], v195 offset:0
    ds_read_b64_tr_b16 a[14:15], v195 offset:16384
    ds_read_b64_tr_b16 a[16:17], v196 offset:0
    ds_read_b64_tr_b16 a[18:19], v196 offset:16384
    ds_read_b64_tr_b16 a[20:21], v197 offset:0
    ds_read_b64_tr_b16 a[22:23], v197 offset:16384
    ds_read_b64_tr_b16 a[24:25], v198 offset:0
    ds_read_b64_tr_b16 a[26:27], v198 offset:16384
    s_waitcnt lgkmcnt(10)
    v_mfma_f32_16x16x32_bf16 v[0:3], a[0:3], a[136:139], 0
    ds_read_b64_tr_b16 a[28:29], v199 offset:0
    s_add_u32 s46, s39, 524288
    v_mfma_f32_16x16x32_bf16 v[4:7], a[0:3], a[140:143], 0
    ds_read_b64_tr_b16 a[30:31], v199 offset:16384
    s_add_u32 m0, s50, 65536
    v_mfma_f32_16x16x32_bf16 v[8:11], a[0:3], a[144:147], 0
    buffer_load_dwordx4 v208, s[20:23], s46 offen offset:0 lds
    v_mfma_f32_16x16x32_bf16 v[96:99], a[4:7], a[136:139], 0
    ds_read_b64_tr_b16 a[0:1], v192 offset:256
    s_add_u32 s55, s63, 1048576
    v_mfma_f32_16x16x32_bf16 v[100:103], a[4:7], a[140:143], 0
    ds_read_b64_tr_b16 a[2:3], v192 offset:16640
    v_mfma_f32_16x16x32_bf16 v[104:107], a[4:7], a[144:147], 0
    s_waitcnt lgkmcnt(10)
    v_mfma_f32_16x16x32_bf16 v[12:15], a[8:11], a[136:139], 0
    buffer_load_dwordx4 v209, s[20:23], s46 offen offset:1024 lds
    v_mfma_f32_16x16x32_bf16 v[16:19], a[8:11], a[140:143], 0
    ds_read_b64_tr_b16 a[4:5], v193 offset:256
    v_mfma_f32_16x16x32_bf16 v[20:23], a[8:11], a[144:147], 0
    buffer_load_dwordx4 v210, s[20:23], s46 offen offset:2048 lds
    v_mfma_f32_16x16x32_bf16 v[108:111], a[12:15], a[136:139], 0
    ds_read_b64_tr_b16 a[6:7], v193 offset:16640
    v_mfma_f32_16x16x32_bf16 v[112:115], a[12:15], a[140:143], 0
    ds_read_b64_tr_b16 a[8:9], v194 offset:256
    v_mfma_f32_16x16x32_bf16 v[116:119], a[12:15], a[144:147], 0
    ds_read_b64_tr_b16 a[10:11], v194 offset:16640
    s_waitcnt lgkmcnt(10)
    v_mfma_f32_16x16x32_bf16 v[24:27], a[16:19], a[136:139], 0
    buffer_load_dwordx4 v211, s[20:23], s46 offen offset:3072 lds
    v_mfma_f32_16x16x32_bf16 v[28:31], a[16:19], a[140:143], 0
    ds_read_b64_tr_b16 a[12:13], v195 offset:256
    s_add_u32 m0, s50, 69632
    v_mfma_f32_16x16x32_bf16 v[32:35], a[16:19], a[144:147], 0
    buffer_load_dwordx4 v212, s[20:23], s46 offen offset:0 lds
    v_mfma_f32_16x16x32_bf16 v[120:123], a[20:23], a[136:139], 0
    ds_read_b64_tr_b16 a[14:15], v195 offset:16640
    v_mfma_f32_16x16x32_bf16 v[124:127], a[20:23], a[140:143], 0
    ds_read_b64_tr_b16 a[16:17], v196 offset:256
    v_mfma_f32_16x16x32_bf16 v[128:131], a[20:23], a[144:147], 0
    ds_read_b64_tr_b16 a[18:19], v196 offset:16640
    s_waitcnt lgkmcnt(10)
    v_mfma_f32_16x16x32_bf16 v[36:39], a[24:27], a[136:139], 0
    buffer_load_dwordx4 v213, s[20:23], s46 offen offset:1024 lds
    v_mfma_f32_16x16x32_bf16 v[40:43], a[24:27], a[140:143], 0
    ds_read_b64_tr_b16 a[20:21], v197 offset:256
    v_mfma_f32_16x16x32_bf16 v[44:47], a[24:27], a[144:147], 0
    buffer_load_dwordx4 v214, s[20:23], s46 offen offset:2048 lds
    v_mfma_f32_16x16x32_bf16 v[132:135], a[28:31], a[136:139], 0
    ds_read_b64_tr_b16 a[22:23], v197 offset:16640
    v_mfma_f32_16x16x32_bf16 v[136:139], a[28:31], a[140:143], 0
    ds_read_b64_tr_b16 a[24:25], v198 offset:256
    v_mfma_f32_16x16x32_bf16 v[140:143], a[28:31], a[144:147], 0
    ds_read_b64_tr_b16 a[26:27], v198 offset:16640
    s_waitcnt lgkmcnt(10)
    v_mfma_f32_16x16x32_bf16 v[48:51], a[0:3], a[136:139], 0
    buffer_load_dwordx4 v215, s[20:23], s46 offen offset:3072 lds
    v_mfma_f32_16x16x32_bf16 v[52:55], a[0:3], a[140:143], 0
    ds_read_b64_tr_b16 a[28:29], v199 offset:256
    v_mfma_f32_16x16x32_bf16 v[56:59], a[0:3], a[144:147], 0
    buffer_load_dword v245, v227, s[20:23], s55 offen
    v_mfma_f32_16x16x32_bf16 v[144:147], a[4:7], a[136:139], 0
    ds_read_b64_tr_b16 a[30:31], v199 offset:16640
    s_add_u32 s55, s40, 256
    v_mfma_f32_16x16x32_bf16 v[148:151], a[4:7], a[140:143], 0
    v_mfma_f32_16x16x32_bf16 v[152:155], a[4:7], a[144:147], 0
    s_waitcnt lgkmcnt(8)
    v_mfma_f32_16x16x32_bf16 v[60:63], a[8:11], a[136:139], 0
    buffer_load_dword v245, v225, s[8:11], s55 offen
    v_mfma_f32_16x16x32_bf16 v[64:67], a[8:11], a[140:143], 0
    v_mfma_f32_16x16x32_bf16 v[68:71], a[8:11], a[144:147], 0
    s_waitcnt vmcnt(10) lgkmcnt(0)
    s_barrier
    v_mfma_f32_16x16x32_bf16 v[156:159], a[12:15], a[136:139], 0
    ds_read_b64_tr_b16 a[0:1], v192 offset:32768
    s_add_u32 s46, s39, 786432
    v_mfma_f32_16x16x32_bf16 v[160:163], a[12:15], a[140:143], 0
    ds_read_b64_tr_b16 a[2:3], v192 offset:49152
    s_add_u32 m0, s50, 0
    v_mfma_f32_16x16x32_bf16 v[164:167], a[12:15], a[144:147], 0
    ds_read_b64_tr_b16 a[4:5], v193 offset:32768
    v_mfma_f32_16x16x32_bf16 v[72:75], a[16:19], a[136:139], 0
    buffer_load_dwordx4 v208, s[20:23], s46 offen offset:0 lds
    v_mfma_f32_16x16x32_bf16 v[76:79], a[16:19], a[140:143], 0
    ds_read_b64_tr_b16 a[6:7], v193 offset:49152
    s_add_u32 s44, s40, 256
    v_mfma_f32_16x16x32_bf16 v[80:83], a[16:19], a[144:147], 0
    ds_read_b64_tr_b16 a[8:9], v194 offset:32768
    v_mfma_f32_16x16x32_bf16 v[168:171], a[20:23], a[136:139], 0
    ds_read_b64_tr_b16 a[10:11], v194 offset:49152
    v_mfma_f32_16x16x32_bf16 v[172:175], a[20:23], a[140:143], 0
    buffer_load_dwordx4 v209, s[20:23], s46 offen offset:1024 lds
    v_mfma_f32_16x16x32_bf16 v[176:179], a[20:23], a[144:147], 0
    ds_read_b64_tr_b16 a[12:13], v195 offset:32768
    v_mfma_f32_16x16x32_bf16 v[84:87], a[24:27], a[136:139], 0
    ds_read_b64_tr_b16 a[14:15], v195 offset:49152
    v_mfma_f32_16x16x32_bf16 v[88:91], a[24:27], a[140:143], 0
    ds_read_b64_tr_b16 a[16:17], v196 offset:32768
    v_mfma_f32_16x16x32_bf16 v[92:95], a[24:27], a[144:147], 0
    buffer_load_dwordx4 v210, s[20:23], s46 offen offset:2048 lds
    v_mfma_f32_16x16x32_bf16 v[180:183], a[28:31], a[136:139], 0
    ds_read_b64_tr_b16 a[18:19], v196 offset:49152
    v_mfma_f32_16x16x32_bf16 v[184:187], a[28:31], a[140:143], 0
    ds_read_b64_tr_b16 a[20:21], v197 offset:32768
    v_mfma_f32_16x16x32_bf16 v[188:191], a[28:31], a[144:147], 0
    ds_read_b64_tr_b16 a[22:23], v197 offset:49152
    s_waitcnt lgkmcnt(8)
    v_mfma_f32_16x16x32_bf16 v[0:3], a[0:3], a[148:151], v[0:3]
    buffer_load_dwordx4 v211, s[20:23], s46 offen offset:3072 lds
    v_mfma_f32_16x16x32_bf16 v[4:7], a[0:3], a[152:155], v[4:7]
    ds_read_b64_tr_b16 a[24:25], v198 offset:32768
    s_add_u32 m0, s50, 4096
    v_mfma_f32_16x16x32_bf16 v[8:11], a[0:3], a[156:159], v[8:11]
    ds_read_b64_tr_b16 a[26:27], v198 offset:49152
    v_mfma_f32_16x16x32_bf16 v[96:99], a[4:7], a[148:151], v[96:99]
    ds_read_b64_tr_b16 a[28:29], v199 offset:32768
    v_mfma_f32_16x16x32_bf16 v[100:103], a[4:7], a[152:155], v[100:103]
    buffer_load_dwordx4 v212, s[20:23], s46 offen offset:0 lds
    v_mfma_f32_16x16x32_bf16 v[104:107], a[4:7], a[156:159], v[104:107]
    ds_read_b64_tr_b16 a[30:31], v199 offset:49152
    s_waitcnt lgkmcnt(8)
    v_mfma_f32_16x16x32_bf16 v[12:15], a[8:11], a[148:151], v[12:15]
    ds_read_b64_tr_b16 a[0:1], v192 offset:33024
    v_mfma_f32_16x16x32_bf16 v[16:19], a[8:11], a[152:155], v[16:19]
    ds_read_b64_tr_b16 a[2:3], v192 offset:49408
    v_mfma_f32_16x16x32_bf16 v[20:23], a[8:11], a[156:159], v[20:23]
    buffer_load_dwordx4 v213, s[20:23], s46 offen offset:1024 lds
    v_mfma_f32_16x16x32_bf16 v[108:111], a[12:15], a[148:151], v[108:111]
    ds_read_b64_tr_b16 a[4:5], v193 offset:33024
    v_mfma_f32_16x16x32_bf16 v[112:115], a[12:15], a[152:155], v[112:115]
    ds_read_b64_tr_b16 a[6:7], v193 offset:49408
    v_mfma_f32_16x16x32_bf16 v[116:119], a[12:15], a[156:159], v[116:119]
    ds_read_b64_tr_b16 a[8:9], v194 offset:33024
    s_waitcnt lgkmcnt(9)
    v_mfma_f32_16x16x32_bf16 v[24:27], a[16:19], a[148:151], v[24:27]
    buffer_load_dwordx4 v214, s[20:23], s46 offen offset:2048 lds
    v_mfma_f32_16x16x32_bf16 v[28:31], a[16:19], a[152:155], v[28:31]
    ds_read_b64_tr_b16 a[10:11], v194 offset:49408
    v_mfma_f32_16x16x32_bf16 v[32:35], a[16:19], a[156:159], v[32:35]
    ds_read_b64_tr_b16 a[12:13], v195 offset:33024
    v_mfma_f32_16x16x32_bf16 v[120:123], a[20:23], a[148:151], v[120:123]
    ds_read_b64_tr_b16 a[14:15], v195 offset:49408
    v_mfma_f32_16x16x32_bf16 v[124:127], a[20:23], a[152:155], v[124:127]
    buffer_load_dwordx4 v215, s[20:23], s46 offen offset:3072 lds
    v_mfma_f32_16x16x32_bf16 v[128:131], a[20:23], a[156:159], v[128:131]
    ds_read_b64_tr_b16 a[16:17], v196 offset:33024
    s_waitcnt lgkmcnt(9)
    v_mfma_f32_16x16x32_bf16 v[36:39], a[24:27], a[148:151], v[36:39]
    ds_read_b64_tr_b16 a[18:19], v196 offset:49408
    s_add_u32 m0, s41, 0
    v_mfma_f32_16x16x32_bf16 v[40:43], a[24:27], a[152:155], v[40:43]
    ds_read_b64_tr_b16 a[20:21], v197 offset:33024
    v_mfma_f32_16x16x32_bf16 v[44:47], a[24:27], a[156:159], v[44:47]
    buffer_load_dwordx4 v218, s[8:11], s44 offen lds
    v_mfma_f32_16x16x32_bf16 v[132:135], a[28:31], a[148:151], v[132:135]
    ds_read_b64_tr_b16 a[22:23], v197 offset:49408
    s_add_u32 s44, s40, 28928
    v_mfma_f32_16x16x32_bf16 v[136:139], a[28:31], a[152:155], v[136:139]
    ds_read_b64_tr_b16 a[24:25], v198 offset:33024
    s_add_u32 m0, s41, 4096
    v_mfma_f32_16x16x32_bf16 v[140:143], a[28:31], a[156:159], v[140:143]
    ds_read_b64_tr_b16 a[26:27], v198 offset:49408
    s_waitcnt lgkmcnt(10)
    v_mfma_f32_16x16x32_bf16 v[48:51], a[0:3], a[148:151], v[48:51]
    buffer_load_dwordx4 v218, s[8:11], s44 offen lds
    v_mfma_f32_16x16x32_bf16 v[52:55], a[0:3], a[152:155], v[52:55]
    ds_read_b64_tr_b16 a[28:29], v199 offset:33024
    s_add_u32 s44, s40, 57600
    v_mfma_f32_16x16x32_bf16 v[56:59], a[0:3], a[156:159], v[56:59]
    ds_read_b64_tr_b16 a[30:31], v199 offset:49408
    s_add_u32 m0, s41, 8192
    v_mfma_f32_16x16x32_bf16 v[144:147], a[4:7], a[148:151], v[144:147]
    ds_read_b128 a[160:163], v216 offset:12288
    v_mfma_f32_16x16x32_bf16 v[148:151], a[4:7], a[152:155], v[148:151]
    buffer_load_dwordx4 v218, s[8:11], s44 offen lds
    v_mfma_f32_16x16x32_bf16 v[152:155], a[4:7], a[156:159], v[152:155]
    ds_read_b128 a[164:167], v216 offset:14336
    s_waitcnt lgkmcnt(10)
    v_mfma_f32_16x16x32_bf16 v[60:63], a[8:11], a[148:151], v[60:63]
    ds_read_b128 a[168:171], v216 offset:16384
    v_mfma_f32_16x16x32_bf16 v[64:67], a[8:11], a[152:155], v[64:67]
    ds_read_b128 a[172:175], v217 offset:12288
    v_mfma_f32_16x16x32_bf16 v[68:71], a[8:11], a[156:159], v[68:71]
    ds_read_b128 a[176:179], v217 offset:14336
    ds_read_b128 a[180:183], v217 offset:16384
    s_waitcnt vmcnt(13) lgkmcnt(0)
    s_barrier
    v_mfma_f32_16x16x32_bf16 v[156:159], a[12:15], a[148:151], v[156:159]
    ds_read_b64_tr_b16 a[0:1], v200 offset:0
    s_add_u32 s46, s39, 1048576
    v_mfma_f32_16x16x32_bf16 v[160:163], a[12:15], a[152:155], v[160:163]
    ds_read_b64_tr_b16 a[2:3], v200 offset:16384
    s_add_u32 m0, s50, 32768
    v_mfma_f32_16x16x32_bf16 v[164:167], a[12:15], a[156:159], v[164:167]
    ds_read_b64_tr_b16 a[4:5], v201 offset:0
    v_mfma_f32_16x16x32_bf16 v[72:75], a[16:19], a[148:151], v[72:75]
    buffer_load_dwordx4 v208, s[20:23], s46 offen offset:0 lds
    v_mfma_f32_16x16x32_bf16 v[76:79], a[16:19], a[152:155], v[76:79]
    ds_read_b64_tr_b16 a[6:7], v201 offset:16384
    s_add_u32 s44, s40, 384
    v_mfma_f32_16x16x32_bf16 v[80:83], a[16:19], a[156:159], v[80:83]
    buffer_load_dwordx4 v209, s[20:23], s46 offen offset:1024 lds
    v_mfma_f32_16x16x32_bf16 v[168:171], a[20:23], a[148:151], v[168:171]
    ds_read_b64_tr_b16 a[8:9], v202 offset:0
    s_add_u32 s45, s42, 0
    v_mfma_f32_16x16x32_bf16 v[172:175], a[20:23], a[152:155], v[172:175]
    buffer_load_dwordx4 v210, s[20:23], s46 offen offset:2048 lds
    v_mfma_f32_16x16x32_bf16 v[176:179], a[20:23], a[156:159], v[176:179]
    ds_read_b64_tr_b16 a[10:11], v202 offset:16384
    v_mfma_f32_16x16x32_bf16 v[84:87], a[24:27], a[148:151], v[84:87]
    buffer_load_dwordx4 v211, s[20:23], s46 offen offset:3072 lds
    v_mfma_f32_16x16x32_bf16 v[88:91], a[24:27], a[152:155], v[88:91]
    ds_read_b64_tr_b16 a[12:13], v203 offset:0
    s_add_u32 m0, s50, 36864
    v_mfma_f32_16x16x32_bf16 v[92:95], a[24:27], a[156:159], v[92:95]
    buffer_load_dwordx4 v212, s[20:23], s46 offen offset:0 lds
    v_mfma_f32_16x16x32_bf16 v[180:183], a[28:31], a[148:151], v[180:183]
    ds_read_b64_tr_b16 a[14:15], v203 offset:16384
    v_mov_b32 v252, 0
    v_mfma_f32_16x16x32_bf16 v[184:187], a[28:31], a[152:155], v[184:187]
    buffer_load_dwordx4 v213, s[20:23], s46 offen offset:1024 lds
    v_mfma_f32_16x16x32_bf16 v[188:191], a[28:31], a[156:159], v[188:191]
    ds_read_b64_tr_b16 a[16:17], v204 offset:0
    s_waitcnt lgkmcnt(5)
    v_mfma_f32_16x16x32_bf16 v[0:3], a[0:3], a[160:163], v[0:3]
    ds_read_b64_tr_b16 a[18:19], v204 offset:16384
    v_mfma_f32_16x16x32_bf16 v[4:7], a[0:3], a[164:167], v[4:7]
    buffer_load_dwordx4 v214, s[20:23], s46 offen offset:2048 lds
    v_mfma_f32_16x16x32_bf16 v[8:11], a[0:3], a[168:171], v[8:11]
    ds_read_b64_tr_b16 a[20:21], v205 offset:0
    v_mfma_f32_16x16x32_bf16 v[96:99], a[4:7], a[160:163], v[96:99]
    ds_read_b64_tr_b16 a[22:23], v205 offset:16384
    v_mfma_f32_16x16x32_bf16 v[100:103], a[4:7], a[164:167], v[100:103]
    buffer_load_dwordx4 v215, s[20:23], s46 offen offset:3072 lds
    v_mfma_f32_16x16x32_bf16 v[104:107], a[4:7], a[168:171], v[104:107]
    ds_read_b64_tr_b16 a[24:25], v206 offset:0
    s_waitcnt lgkmcnt(5)
    v_mfma_f32_16x16x32_bf16 v[12:15], a[8:11], a[160:163], v[12:15]
    ds_read_b64_tr_b16 a[26:27], v206 offset:16384
    s_add_u32 m0, s41, 12288
    v_mfma_f32_16x16x32_bf16 v[16:19], a[8:11], a[164:167], v[16:19]
    buffer_load_dwordx4 v218, s[8:11], s44 offen lds
    v_mfma_f32_16x16x32_bf16 v[20:23], a[8:11], a[168:171], v[20:23]
    ds_read_b64_tr_b16 a[28:29], v207 offset:0
    s_add_u32 s44, s40, 29056
    v_mfma_f32_16x16x32_bf16 v[108:111], a[12:15], a[160:163], v[108:111]
    ds_read_b64_tr_b16 a[30:31], v207 offset:16384
    s_add_u32 m0, s41, 16384
    v_mfma_f32_16x16x32_bf16 v[112:115], a[12:15], a[164:167], v[112:115]
    buffer_load_dwordx4 v218, s[8:11], s44 offen lds
    v_mfma_f32_16x16x32_bf16 v[116:119], a[12:15], a[168:171], v[116:119]
    ds_read_b64_tr_b16 a[0:1], v200 offset:256
    s_waitcnt lgkmcnt(5)
    v_mfma_f32_16x16x32_bf16 v[24:27], a[16:19], a[160:163], v[24:27]
    ds_read_b64_tr_b16 a[2:3], v200 offset:16640
    s_add_u32 s44, s40, 57728
    v_mfma_f32_16x16x32_bf16 v[28:31], a[16:19], a[164:167], v[28:31]
    ds_read_b64_tr_b16 a[4:5], v201 offset:256
    s_add_u32 m0, s41, 20480
    v_mfma_f32_16x16x32_bf16 v[32:35], a[16:19], a[168:171], v[32:35]
    buffer_load_dwordx4 v218, s[8:11], s44 offen lds
    v_mfma_f32_16x16x32_bf16 v[120:123], a[20:23], a[160:163], v[120:123]
    ds_read_b64_tr_b16 a[6:7], v201 offset:16640
    s_add_u32 m0, s43, 0
    v_mfma_f32_16x16x32_bf16 v[124:127], a[20:23], a[164:167], v[124:127]
    buffer_load_dwordx4 v223, s[12:15], s45 offen offset:0 nt lds
    v_mfma_f32_16x16x32_bf16 v[128:131], a[20:23], a[168:171], v[128:131]
    ds_read_b64_tr_b16 a[8:9], v202 offset:256
    s_waitcnt lgkmcnt(5)
    v_mfma_f32_16x16x32_bf16 v[36:39], a[24:27], a[160:163], v[36:39]
    ds_read_b64_tr_b16 a[10:11], v202 offset:16640
    s_add_u32 s45, s42, 1008
    v_mfma_f32_16x16x32_bf16 v[40:43], a[24:27], a[164:167], v[40:43]
    buffer_load_dwordx4 v223, s[12:15], s45 offen offset:1040 nt lds
    v_mfma_f32_16x16x32_bf16 v[44:47], a[24:27], a[168:171], v[44:47]
    ds_read_b64_tr_b16 a[12:13], v203 offset:256
    s_add_u32 s45, s42, 2016
    v_mfma_f32_16x16x32_bf16 v[132:135], a[28:31], a[160:163], v[132:135]
    ds_read_b64_tr_b16 a[14:15], v203 offset:16640
    v_mfma_f32_16x16x32_bf16 v[136:139], a[28:31], a[164:167], v[136:139]
    buffer_load_dwordx4 v223, s[12:15], s45 offen offset:2080 nt lds
    v_mfma_f32_16x16x32_bf16 v[140:143], a[28:31], a[168:171], v[140:143]
    ds_read_b64_tr_b16 a[16:17], v204 offset:256
    s_waitcnt lgkmcnt(5)
    v_mfma_f32_16x16x32_bf16 v[48:51], a[0:3], a[160:163], v[48:51]
    ds_read_b64_tr_b16 a[18:19], v204 offset:16640
    s_add_u32 s45, s42, 3024
    v_mfma_f32_16x16x32_bf16 v[52:55], a[0:3], a[164:167], v[52:55]
    buffer_load_dwordx4 v223, s[12:15], s45 offen offset:3120 nt lds
    v_mfma_f32_16x16x32_bf16 v[56:59], a[0:3], a[168:171], v[56:59]
    ds_read_b64_tr_b16 a[20:21], v205 offset:256
    s_add_u32 m0, s43, 4160
    v_mfma_f32_16x16x32_bf16 v[144:147], a[4:7], a[160:163], v[144:147]
    ds_read_b64_tr_b16 a[22:23], v205 offset:16640
    s_add_u32 s45, s42, 256
    v_mfma_f32_16x16x32_bf16 v[148:151], a[4:7], a[164:167], v[148:151]
    buffer_load_dwordx4 v223, s[12:15], s45 offen offset:0 nt lds
    v_mfma_f32_16x16x32_bf16 v[152:155], a[4:7], a[168:171], v[152:155]
    ds_read_b64_tr_b16 a[24:25], v206 offset:256
    s_waitcnt lgkmcnt(5)
    v_mfma_f32_16x16x32_bf16 v[60:63], a[8:11], a[160:163], v[60:63]
    ds_read_b64_tr_b16 a[26:27], v206 offset:16640
    s_add_u32 s45, s42, 1264
    v_mfma_f32_16x16x32_bf16 v[64:67], a[8:11], a[164:167], v[64:67]
    buffer_load_dwordx4 v223, s[12:15], s45 offen offset:1040 nt lds
    v_mfma_f32_16x16x32_bf16 v[68:71], a[8:11], a[168:171], v[68:71]
    ds_read_b64_tr_b16 a[28:29], v207 offset:256
    s_add_u32 s45, s42, 2272
    ds_read_b64_tr_b16 a[30:31], v207 offset:16640
    buffer_load_dwordx4 v223, s[12:15], s45 offen offset:2080 nt lds
    s_add_u32 s45, s42, 3280
    buffer_load_dwordx4 v223, s[12:15], s45 offen offset:3120 nt lds
    buffer_load_dword v252, v252, s[4:7], s95 offen sc1
    s_waitcnt vmcnt(20) lgkmcnt(0)
    s_barrier
    v_mfma_f32_16x16x32_bf16 v[156:159], a[12:15], a[160:163], v[156:159]
    ds_read_b64_tr_b16 a[0:1], v192 offset:0
    s_add_u32 s46, s39, 1310720
    v_mfma_f32_16x16x32_bf16 v[160:163], a[12:15], a[164:167], v[160:163]
    ds_read_b64_tr_b16 a[2:3], v192 offset:16384
    s_add_u32 m0, s50, 65536
    v_mfma_f32_16x16x32_bf16 v[164:167], a[12:15], a[168:171], v[164:167]
    ds_read_b64_tr_b16 a[4:5], v193 offset:0
    v_mfma_f32_16x16x32_bf16 v[72:75], a[16:19], a[160:163], v[72:75]
    buffer_load_dwordx4 v208, s[20:23], s46 offen offset:0 lds
    v_mfma_f32_16x16x32_bf16 v[76:79], a[16:19], a[164:167], v[76:79]
    ds_read_b64_tr_b16 a[6:7], v193 offset:16384
    s_lshl_b32 s86, s35, 5
    v_mfma_f32_16x16x32_bf16 v[80:83], a[16:19], a[168:171], v[80:83]
    ds_read_b64_tr_b16 a[8:9], v194 offset:0
    s_add_u32 s86, s86, s37
    v_mfma_f32_16x16x32_bf16 v[168:171], a[20:23], a[160:163], v[168:171]
    ds_read_b64_tr_b16 a[10:11], v194 offset:16384
    s_lshl_b32 s72, s86, 2
    v_mfma_f32_16x16x32_bf16 v[172:175], a[20:23], a[164:167], v[172:175]
    ds_read_b64_tr_b16 a[12:13], v195 offset:0
    s_mul_i32 s84, s86, 43008
    v_mfma_f32_16x16x32_bf16 v[176:179], a[20:23], a[168:171], v[176:179]
    ds_read_b64_tr_b16 a[14:15], v195 offset:16384
    v_mfma_f32_16x16x32_bf16 v[84:87], a[24:27], a[160:163], v[84:87]
    buffer_load_dwordx4 v209, s[20:23], s46 offen offset:1024 lds
    v_mfma_f32_16x16x32_bf16 v[88:91], a[24:27], a[164:167], v[88:91]
    ds_read_b64_tr_b16 a[16:17], v196 offset:0
    s_lshr_b32 s85, s36, 1
    v_mfma_f32_16x16x32_bf16 v[92:95], a[24:27], a[168:171], v[92:95]
    ds_read_b64_tr_b16 a[18:19], v196 offset:16384
    s_lshl_b32 s86, s32, 3
    v_mfma_f32_16x16x32_bf16 v[180:183], a[28:31], a[160:163], v[180:183]
    ds_read_b64_tr_b16 a[20:21], v197 offset:0
    s_add_u32 s85, s85, s86
    v_mfma_f32_16x16x32_bf16 v[184:187], a[28:31], a[164:167], v[184:187]
    ds_read_b64_tr_b16 a[22:23], v197 offset:16384
    s_add_u32 s60, s85, 0
    v_mfma_f32_16x16x32_bf16 v[188:191], a[28:31], a[168:171], v[188:191]
    ds_read_b64_tr_b16 a[24:25], v198 offset:0
    s_waitcnt lgkmcnt(9)
    v_mfma_f32_16x16x32_bf16 v[0:3], a[0:3], a[172:175], v[0:3]
    buffer_load_dwordx4 v210, s[20:23], s46 offen offset:2048 lds
    v_mfma_f32_16x16x32_bf16 v[4:7], a[0:3], a[176:179], v[4:7]
    ds_read_b64_tr_b16 a[26:27], v198 offset:16384
    s_mul_i32 s74, s60, 43
    v_mfma_f32_16x16x32_bf16 v[8:11], a[0:3], a[180:183], v[8:11]
    ds_read_b64_tr_b16 a[28:29], v199 offset:0
    s_lshr_b32 s74, s74, 9
    v_mfma_f32_16x16x32_bf16 v[96:99], a[4:7], a[172:175], v[96:99]
    ds_read_b64_tr_b16 a[30:31], v199 offset:16384
    s_mul_i32 s75, s74, 12
    v_mfma_f32_16x16x32_bf16 v[100:103], a[4:7], a[176:179], v[100:103]
    ds_read_b64_tr_b16 a[0:1], v192 offset:256
    s_sub_u32 s75, s60, s75
    v_mfma_f32_16x16x32_bf16 v[104:107], a[4:7], a[180:183], v[104:107]
    ds_read_b64_tr_b16 a[2:3], v192 offset:16640
    s_waitcnt lgkmcnt(10)
    v_mfma_f32_16x16x32_bf16 v[12:15], a[8:11], a[172:175], v[12:15]
    buffer_load_dwordx4 v211, s[20:23], s46 offen offset:3072 lds
    v_mfma_f32_16x16x32_bf16 v[16:19], a[8:11], a[176:179], v[16:19]
    ds_read_b64_tr_b16 a[4:5], v193 offset:256
    s_add_u32 m0, s50, 69632
    v_mfma_f32_16x16x32_bf16 v[20:23], a[8:11], a[180:183], v[20:23]
    ds_read_b64_tr_b16 a[6:7], v193 offset:16640
    s_mul_i32 s86, s75, 43
    v_mfma_f32_16x16x32_bf16 v[108:111], a[12:15], a[172:175], v[108:111]
    ds_read_b64_tr_b16 a[8:9], v194 offset:256
    s_lshr_b32 s86, s86, 8
    v_mfma_f32_16x16x32_bf16 v[112:115], a[12:15], a[176:179], v[112:115]
    ds_read_b64_tr_b16 a[10:11], v194 offset:16640
    s_mul_i32 s87, s86, 6
    v_mfma_f32_16x16x32_bf16 v[116:119], a[12:15], a[180:183], v[116:119]
    ds_read_b128 a[184:187], v216 offset:0
    s_waitcnt lgkmcnt(11)
    v_mfma_f32_16x16x32_bf16 v[24:27], a[16:19], a[172:175], v[24:27]
    buffer_load_dwordx4 v212, s[20:23], s46 offen offset:0 lds
    v_mfma_f32_16x16x32_bf16 v[28:31], a[16:19], a[176:179], v[28:31]
    ds_read_b64_tr_b16 a[12:13], v195 offset:256
    s_sub_u32 s75, s75, s87
    v_mfma_f32_16x16x32_bf16 v[32:35], a[16:19], a[180:183], v[32:35]
    ds_read_b64_tr_b16 a[14:15], v195 offset:16640
    s_mul_i32 s64, s74, 6
    v_mfma_f32_16x16x32_bf16 v[120:123], a[20:23], a[172:175], v[120:123]
    ds_read_b64_tr_b16 a[16:17], v196 offset:256
    s_add_u32 s64, s64, s75
    v_mfma_f32_16x16x32_bf16 v[124:127], a[20:23], a[176:179], v[124:127]
    ds_read_b64_tr_b16 a[18:19], v196 offset:16640
    s_lshl_b32 s64, s64, 10
    v_mfma_f32_16x16x32_bf16 v[128:131], a[20:23], a[180:183], v[128:131]
    ds_read_b128 a[188:191], v216 offset:2048
    s_waitcnt lgkmcnt(12)
    v_mfma_f32_16x16x32_bf16 v[36:39], a[24:27], a[172:175], v[36:39]
    buffer_load_dwordx4 v213, s[20:23], s46 offen offset:1024 lds
    v_mfma_f32_16x16x32_bf16 v[40:43], a[24:27], a[176:179], v[40:43]
    ds_read_b64_tr_b16 a[20:21], v197 offset:256
    s_mul_i32 s87, s86, 43008
    v_mfma_f32_16x16x32_bf16 v[44:47], a[24:27], a[180:183], v[44:47]
    ds_read_b64_tr_b16 a[22:23], v197 offset:16640
    s_add_u32 s64, s64, s87
    v_mfma_f32_16x16x32_bf16 v[132:135], a[28:31], a[172:175], v[132:135]
    ds_read_b64_tr_b16 a[24:25], v198 offset:256
    s_add_u32 s64, s64, s84
    v_mfma_f32_16x16x32_bf16 v[136:139], a[28:31], a[176:179], v[136:139]
    buffer_load_dwordx4 v214, s[20:23], s46 offen offset:2048 lds
    v_mfma_f32_16x16x32_bf16 v[140:143], a[28:31], a[180:183], v[140:143]
    ds_read_b64_tr_b16 a[26:27], v198 offset:16640
    s_waitcnt lgkmcnt(12)
    v_mfma_f32_16x16x32_bf16 v[48:51], a[0:3], a[172:175], v[48:51]
    ds_read_b64_tr_b16 a[28:29], v199 offset:256
    s_mul_i32 s87, s75, 43
    v_mfma_f32_16x16x32_bf16 v[52:55], a[0:3], a[176:179], v[52:55]
    ds_read_b64_tr_b16 a[30:31], v199 offset:16640
    s_lshr_b32 s87, s87, 7
    v_mfma_f32_16x16x32_bf16 v[56:59], a[0:3], a[180:183], v[56:59]
    ds_read_b128 a[192:195], v216 offset:4096
    s_lshl_b32 s74, s74, 1
    v_mfma_f32_16x16x32_bf16 v[144:147], a[4:7], a[172:175], v[144:147]
    buffer_load_dwordx4 v215, s[20:23], s46 offen offset:3072 lds
    v_mfma_f32_16x16x32_bf16 v[148:151], a[4:7], a[176:179], v[148:151]
    ds_read_b128 a[196:199], v217 offset:0
    s_add_u32 s74, s74, s87
    v_mfma_f32_16x16x32_bf16 v[152:155], a[4:7], a[180:183], v[152:155]
    ds_read_b128 a[200:203], v217 offset:2048
    s_waitcnt lgkmcnt(12)
    v_mfma_f32_16x16x32_bf16 v[60:63], a[8:11], a[172:175], v[60:63]
    ds_read_b128 a[204:207], v217 offset:4096
    s_lshl_b32 s74, s74, 6
    v_mfma_f32_16x16x32_bf16 v[64:67], a[8:11], a[176:179], v[64:67]
    s_mul_i32 s87, s87, 3
    s_sub_u32 s75, s75, s87
    v_mfma_f32_16x16x32_bf16 v[68:71], a[8:11], a[180:183], v[68:71]
    s_add_u32 s86, s86, s37
    s_mul_i32 s86, s86, 3
    s_add_u32 s86, s86, s75
    s_mul_i32 s68, s86, 28672
    s_add_u32 s68, s68, s74
    s_mul_i32 s86, s35, 896
    s_waitcnt vmcnt(17) lgkmcnt(0)
    s_barrier
    v_mfma_f32_16x16x32_bf16 v[156:159], a[12:15], a[172:175], v[156:159]
    ds_read_b64_tr_b16 a[0:1], v192 offset:32768
    s_add_u32 s46, s39, 1572864
    v_mfma_f32_16x16x32_bf16 v[160:163], a[12:15], a[176:179], v[160:163]
    ds_read_b64_tr_b16 a[2:3], v192 offset:49152
    s_add_u32 m0, s50, 0
    v_mfma_f32_16x16x32_bf16 v[164:167], a[12:15], a[180:183], v[164:167]
    ds_read_b64_tr_b16 a[4:5], v193 offset:32768
    v_mfma_f32_16x16x32_bf16 v[72:75], a[16:19], a[172:175], v[72:75]
    buffer_load_dwordx4 v208, s[20:23], s46 offen offset:0 lds
    v_mfma_f32_16x16x32_bf16 v[76:79], a[16:19], a[176:179], v[76:79]
    ds_read_b64_tr_b16 a[6:7], v193 offset:49152
    s_add_u32 s68, s68, s86
    v_mfma_f32_16x16x32_bf16 v[80:83], a[16:19], a[180:183], v[80:83]
    ds_read_b64_tr_b16 a[8:9], v194 offset:32768
    s_add_u32 s86, s60, 104
    v_mfma_f32_16x16x32_bf16 v[168:171], a[20:23], a[172:175], v[168:171]
    ds_read_b64_tr_b16 a[10:11], v194 offset:49152
    s_lshr_b32 s86, s86, 7
    v_mfma_f32_16x16x32_bf16 v[172:175], a[20:23], a[176:179], v[172:175]
    buffer_load_dwordx4 v209, s[20:23], s46 offen offset:1024 lds
    v_mfma_f32_16x16x32_bf16 v[176:179], a[20:23], a[180:183], v[176:179]
    ds_read_b64_tr_b16 a[12:13], v195 offset:32768
    v_mfma_f32_16x16x32_bf16 v[84:87], a[24:27], a[172:175], v[84:87]
    ds_read_b64_tr_b16 a[14:15], v195 offset:49152
    s_mul_i32 s86, s86, 2147479552
    v_mfma_f32_16x16x32_bf16 v[88:91], a[24:27], a[176:179], v[88:91]
    ds_read_b64_tr_b16 a[16:17], v196 offset:32768
    s_add_u32 s64, s64, s86
    v_mfma_f32_16x16x32_bf16 v[92:95], a[24:27], a[180:183], v[92:95]
    buffer_load_dwordx4 v210, s[20:23], s46 offen offset:2048 lds
    v_mfma_f32_16x16x32_bf16 v[180:183], a[28:31], a[172:175], v[180:183]
    ds_read_b64_tr_b16 a[18:19], v196 offset:49152
    s_add_u32 s68, s68, s86
    v_mfma_f32_16x16x32_bf16 v[184:187], a[28:31], a[176:179], v[184:187]
    ds_read_b64_tr_b16 a[20:21], v197 offset:32768
    s_add_u32 s60, s85, 24
    v_mfma_f32_16x16x32_bf16 v[188:191], a[28:31], a[180:183], v[188:191]
    ds_read_b64_tr_b16 a[22:23], v197 offset:49152
    s_waitcnt lgkmcnt(8)
    v_mfma_f32_16x16x32_bf16 v[0:3], a[0:3], a[184:187], v[0:3]
    buffer_load_dwordx4 v211, s[20:23], s46 offen offset:3072 lds
    v_mfma_f32_16x16x32_bf16 v[4:7], a[0:3], a[188:191], v[4:7]
    ds_read_b64_tr_b16 a[24:25], v198 offset:32768
    s_add_u32 m0, s50, 4096
    v_mfma_f32_16x16x32_bf16 v[8:11], a[0:3], a[192:195], v[8:11]
    ds_read_b64_tr_b16 a[26:27], v198 offset:49152
    s_mul_i32 s74, s60, 43
    v_mfma_f32_16x16x32_bf16 v[96:99], a[4:7], a[184:187], v[96:99]
    ds_read_b64_tr_b16 a[28:29], v199 offset:32768
    s_lshr_b32 s74, s74, 9
    v_mfma_f32_16x16x32_bf16 v[100:103], a[4:7], a[188:191], v[100:103]
    buffer_load_dwordx4 v212, s[20:23], s46 offen offset:0 lds
    v_mfma_f32_16x16x32_bf16 v[104:107], a[4:7], a[192:195], v[104:107]
    ds_read_b64_tr_b16 a[30:31], v199 offset:49152
    s_waitcnt lgkmcnt(8)
    v_mfma_f32_16x16x32_bf16 v[12:15], a[8:11], a[184:187], v[12:15]
    ds_read_b64_tr_b16 a[0:1], v192 offset:33024
    s_mul_i32 s75, s74, 12
    v_mfma_f32_16x16x32_bf16 v[16:19], a[8:11], a[188:191], v[16:19]
    ds_read_b64_tr_b16 a[2:3], v192 offset:49408
    s_sub_u32 s75, s60, s75
    v_mfma_f32_16x16x32_bf16 v[20:23], a[8:11], a[192:195], v[20:23]
    buffer_load_dwordx4 v213, s[20:23], s46 offen offset:1024 lds
    v_mfma_f32_16x16x32_bf16 v[108:111], a[12:15], a[184:187], v[108:111]
    ds_read_b64_tr_b16 a[4:5], v193 offset:33024
    s_mul_i32 s86, s75, 43
    v_mfma_f32_16x16x32_bf16 v[112:115], a[12:15], a[188:191], v[112:115]
    ds_read_b64_tr_b16 a[6:7], v193 offset:49408
    s_lshr_b32 s86, s86, 8
    v_mfma_f32_16x16x32_bf16 v[116:119], a[12:15], a[192:195], v[116:119]
    ds_read_b64_tr_b16 a[8:9], v194 offset:33024
    s_waitcnt lgkmcnt(9)
    v_mfma_f32_16x16x32_bf16 v[24:27], a[16:19], a[184:187], v[24:27]
    buffer_load_dwordx4 v214, s[20:23], s46 offen offset:2048 lds
    v_mfma_f32_16x16x32_bf16 v[28:31], a[16:19], a[188:191], v[28:31]
    ds_read_b64_tr_b16 a[10:11], v194 offset:49408
    s_mul_i32 s87, s86, 6
    v_mfma_f32_16x16x32_bf16 v[32:35], a[16:19], a[192:195], v[32:35]
    ds_read_b64_tr_b16 a[12:13], v195 offset:33024
    s_sub_u32 s75, s75, s87
    v_mfma_f32_16x16x32_bf16 v[120:123], a[20:23], a[184:187], v[120:123]
    ds_read_b64_tr_b16 a[14:15], v195 offset:49408
    s_mul_i32 s65, s74, 6
    v_mfma_f32_16x16x32_bf16 v[124:127], a[20:23], a[188:191], v[124:127]
    ds_read_b64_tr_b16 a[16:17], v196 offset:33024
    s_add_u32 s65, s65, s75
    v_mfma_f32_16x16x32_bf16 v[128:131], a[20:23], a[192:195], v[128:131]
    ds_read_b64_tr_b16 a[18:19], v196 offset:49408
    s_waitcnt lgkmcnt(10)
    v_mfma_f32_16x16x32_bf16 v[36:39], a[24:27], a[184:187], v[36:39]
    buffer_load_dwordx4 v215, s[20:23], s46 offen offset:3072 lds
    v_mfma_f32_16x16x32_bf16 v[40:43], a[24:27], a[188:191], v[40:43]
    ds_read_b64_tr_b16 a[20:21], v197 offset:33024
    s_lshl_b32 s65, s65, 10
    v_mfma_f32_16x16x32_bf16 v[44:47], a[24:27], a[192:195], v[44:47]
    ds_read_b64_tr_b16 a[22:23], v197 offset:49408
    s_mul_i32 s87, s86, 43008
    v_mfma_f32_16x16x32_bf16 v[132:135], a[28:31], a[184:187], v[132:135]
    ds_read_b64_tr_b16 a[24:25], v198 offset:33024
    s_add_u32 s65, s65, s87
    v_mfma_f32_16x16x32_bf16 v[136:139], a[28:31], a[188:191], v[136:139]
    ds_read_b64_tr_b16 a[26:27], v198 offset:49408
    s_add_u32 s65, s65, s84
    v_mfma_f32_16x16x32_bf16 v[140:143], a[28:31], a[192:195], v[140:143]
    ds_read_b128 a[208:211], v216 offset:12288
    s_waitcnt lgkmcnt(11)
    v_mfma_f32_16x16x32_bf16 v[48:51], a[0:3], a[184:187], v[48:51]
    ds_read_b64_tr_b16 a[28:29], v199 offset:33024
    s_mul_i32 s87, s75, 43
    v_mfma_f32_16x16x32_bf16 v[52:55], a[0:3], a[188:191], v[52:55]
    ds_read_b64_tr_b16 a[30:31], v199 offset:49408
    s_lshr_b32 s87, s87, 7
    v_mfma_f32_16x16x32_bf16 v[56:59], a[0:3], a[192:195], v[56:59]
    ds_read_b128 a[212:215], v216 offset:14336
    s_lshl_b32 s74, s74, 1
    v_mfma_f32_16x16x32_bf16 v[144:147], a[4:7], a[184:187], v[144:147]
    ds_read_b128 a[216:219], v216 offset:16384
    s_add_u32 s74, s74, s87
    v_mfma_f32_16x16x32_bf16 v[148:151], a[4:7], a[188:191], v[148:151]
    ds_read_b128 a[220:223], v217 offset:12288
    s_lshl_b32 s74, s74, 6
    v_mfma_f32_16x16x32_bf16 v[152:155], a[4:7], a[192:195], v[152:155]
    ds_read_b128 a[224:227], v217 offset:14336
    s_waitcnt lgkmcnt(13)
    v_mfma_f32_16x16x32_bf16 v[60:63], a[8:11], a[184:187], v[60:63]
    ds_read_b128 a[228:231], v217 offset:16384
    s_mul_i32 s87, s87, 3
    v_mfma_f32_16x16x32_bf16 v[64:67], a[8:11], a[188:191], v[64:67]
    s_sub_u32 s75, s75, s87
    s_add_u32 s86, s86, s37
    v_mfma_f32_16x16x32_bf16 v[68:71], a[8:11], a[192:195], v[68:71]
    s_mul_i32 s86, s86, 3
    s_add_u32 s86, s86, s75
    s_mul_i32 s69, s86, 28672
    s_add_u32 s69, s69, s74
    s_mul_i32 s86, s35, 896
    s_add_u32 s69, s69, s86
    s_add_u32 s55, s63, 2097152
    buffer_load_dword v245, v224, s[20:23], s55 offen
    s_add_u32 s55, s40, 512
    buffer_load_dword v245, v226, s[8:11], s55 offen
    s_waitcnt vmcnt(10) lgkmcnt(0)
    s_barrier
    v_mfma_f32_16x16x32_bf16 v[156:159], a[12:15], a[184:187], v[156:159]
    ds_read_b64_tr_b16 a[0:1], v200 offset:0
    s_add_u32 s46, s39, 1835008
    v_mfma_f32_16x16x32_bf16 v[160:163], a[12:15], a[188:191], v[160:163]
    ds_read_b64_tr_b16 a[2:3], v200 offset:16384
    s_add_u32 m0, s50, 32768
    v_mfma_f32_16x16x32_bf16 v[164:167], a[12:15], a[192:195], v[164:167]
    ds_read_b64_tr_b16 a[4:5], v201 offset:0
    v_mfma_f32_16x16x32_bf16 v[72:75], a[16:19], a[184:187], v[72:75]
    buffer_load_dwordx4 v208, s[20:23], s46 offen offset:0 lds
    v_mfma_f32_16x16x32_bf16 v[76:79], a[16:19], a[188:191], v[76:79]
    ds_read_b64_tr_b16 a[6:7], v201 offset:16384
    s_add_u32 s44, s40, 512
    v_mfma_f32_16x16x32_bf16 v[80:83], a[16:19], a[192:195], v[80:83]
    ds_read_b64_tr_b16 a[8:9], v202 offset:0
    v_mfma_f32_16x16x32_bf16 v[168:171], a[20:23], a[184:187], v[168:171]
    ds_read_b64_tr_b16 a[10:11], v202 offset:16384
    v_mfma_f32_16x16x32_bf16 v[172:175], a[20:23], a[188:191], v[172:175]
    buffer_load_dwordx4 v209, s[20:23], s46 offen offset:1024 lds
    v_mfma_f32_16x16x32_bf16 v[176:179], a[20:23], a[192:195], v[176:179]
    ds_read_b64_tr_b16 a[12:13], v203 offset:0
    v_mfma_f32_16x16x32_bf16 v[84:87], a[24:27], a[184:187], v[84:87]
    ds_read_b64_tr_b16 a[14:15], v203 offset:16384
    v_mfma_f32_16x16x32_bf16 v[88:91], a[24:27], a[188:191], v[88:91]
    ds_read_b64_tr_b16 a[16:17], v204 offset:0
    v_mfma_f32_16x16x32_bf16 v[92:95], a[24:27], a[192:195], v[92:95]
    buffer_load_dwordx4 v210, s[20:23], s46 offen offset:2048 lds
    v_mfma_f32_16x16x32_bf16 v[180:183], a[28:31], a[184:187], v[180:183]
    ds_read_b64_tr_b16 a[18:19], v204 offset:16384
    v_mfma_f32_16x16x32_bf16 v[184:187], a[28:31], a[188:191], v[184:187]
    ds_read_b64_tr_b16 a[20:21], v205 offset:0
    v_mfma_f32_16x16x32_bf16 v[188:191], a[28:31], a[192:195], v[188:191]
    ds_read_b64_tr_b16 a[22:23], v205 offset:16384
    s_waitcnt lgkmcnt(8)
    v_mfma_f32_16x16x32_bf16 v[0:3], a[0:3], a[196:199], v[0:3]
    buffer_load_dwordx4 v211, s[20:23], s46 offen offset:3072 lds
    v_mfma_f32_16x16x32_bf16 v[4:7], a[0:3], a[200:203], v[4:7]
    ds_read_b64_tr_b16 a[24:25], v206 offset:0
    s_add_u32 m0, s50, 36864
    v_mfma_f32_16x16x32_bf16 v[8:11], a[0:3], a[204:207], v[8:11]
    ds_read_b64_tr_b16 a[26:27], v206 offset:16384
    v_mfma_f32_16x16x32_bf16 v[96:99], a[4:7], a[196:199], v[96:99]
    ds_read_b64_tr_b16 a[28:29], v207 offset:0
    v_mfma_f32_16x16x32_bf16 v[100:103], a[4:7], a[200:203], v[100:103]
    buffer_load_dwordx4 v212, s[20:23], s46 offen offset:0 lds
    v_mfma_f32_16x16x32_bf16 v[104:107], a[4:7], a[204:207], v[104:107]
    ds_read_b64_tr_b16 a[30:31], v207 offset:16384
    s_waitcnt lgkmcnt(8)
    v_mfma_f32_16x16x32_bf16 v[12:15], a[8:11], a[196:199], v[12:15]
    ds_read_b64_tr_b16 a[0:1], v200 offset:256
    v_mfma_f32_16x16x32_bf16 v[16:19], a[8:11], a[200:203], v[16:19]
    ds_read_b64_tr_b16 a[2:3], v200 offset:16640
    v_mfma_f32_16x16x32_bf16 v[20:23], a[8:11], a[204:207], v[20:23]
    buffer_load_dwordx4 v213, s[20:23], s46 offen offset:1024 lds
    v_mfma_f32_16x16x32_bf16 v[108:111], a[12:15], a[196:199], v[108:111]
    ds_read_b64_tr_b16 a[4:5], v201 offset:256
    v_mfma_f32_16x16x32_bf16 v[112:115], a[12:15], a[200:203], v[112:115]
    ds_read_b64_tr_b16 a[6:7], v201 offset:16640
    v_mfma_f32_16x16x32_bf16 v[116:119], a[12:15], a[204:207], v[116:119]
    ds_read_b64_tr_b16 a[8:9], v202 offset:256
    s_waitcnt lgkmcnt(9)
    v_mfma_f32_16x16x32_bf16 v[24:27], a[16:19], a[196:199], v[24:27]
    buffer_load_dwordx4 v214, s[20:23], s46 offen offset:2048 lds
    v_mfma_f32_16x16x32_bf16 v[28:31], a[16:19], a[200:203], v[28:31]
    ds_read_b64_tr_b16 a[10:11], v202 offset:16640
    v_mfma_f32_16x16x32_bf16 v[32:35], a[16:19], a[204:207], v[32:35]
    ds_read_b64_tr_b16 a[12:13], v203 offset:256
    v_mfma_f32_16x16x32_bf16 v[120:123], a[20:23], a[196:199], v[120:123]
    ds_read_b64_tr_b16 a[14:15], v203 offset:16640
    v_mfma_f32_16x16x32_bf16 v[124:127], a[20:23], a[200:203], v[124:127]
    buffer_load_dwordx4 v215, s[20:23], s46 offen offset:3072 lds
    v_mfma_f32_16x16x32_bf16 v[128:131], a[20:23], a[204:207], v[128:131]
    ds_read_b64_tr_b16 a[16:17], v204 offset:256
    s_waitcnt lgkmcnt(9)
    v_mfma_f32_16x16x32_bf16 v[36:39], a[24:27], a[196:199], v[36:39]
    ds_read_b64_tr_b16 a[18:19], v204 offset:16640
    s_add_u32 m0, s41, 0
    v_mfma_f32_16x16x32_bf16 v[40:43], a[24:27], a[200:203], v[40:43]
    ds_read_b64_tr_b16 a[20:21], v205 offset:256
    v_mfma_f32_16x16x32_bf16 v[44:47], a[24:27], a[204:207], v[44:47]
    buffer_load_dwordx4 v218, s[8:11], s44 offen lds
    v_mfma_f32_16x16x32_bf16 v[132:135], a[28:31], a[196:199], v[132:135]
    ds_read_b64_tr_b16 a[22:23], v205 offset:16640
    s_add_u32 s44, s40, 29184
    v_mfma_f32_16x16x32_bf16 v[136:139], a[28:31], a[200:203], v[136:139]
    ds_read_b64_tr_b16 a[24:25], v206 offset:256
    s_add_u32 m0, s41, 4096
    v_mfma_f32_16x16x32_bf16 v[140:143], a[28:31], a[204:207], v[140:143]
    ds_read_b64_tr_b16 a[26:27], v206 offset:16640
    s_waitcnt lgkmcnt(10)
    v_mfma_f32_16x16x32_bf16 v[48:51], a[0:3], a[196:199], v[48:51]
    buffer_load_dwordx4 v218, s[8:11], s44 offen lds
    v_mfma_f32_16x16x32_bf16 v[52:55], a[0:3], a[200:203], v[52:55]
    ds_read_b64_tr_b16 a[28:29], v207 offset:256
    s_add_u32 s44, s40, 57856
    v_mfma_f32_16x16x32_bf16 v[56:59], a[0:3], a[204:207], v[56:59]
    ds_read_b64_tr_b16 a[30:31], v207 offset:16640
    s_add_u32 m0, s41, 8192
    v_mfma_f32_16x16x32_bf16 v[144:147], a[4:7], a[196:199], v[144:147]
    ds_read_b64 a[40:41], v219 offset:0
    v_mfma_f32_16x16x32_bf16 v[148:151], a[4:7], a[200:203], v[148:151]
    buffer_load_dwordx4 v218, s[8:11], s44 offen lds
    v_mfma_f32_16x16x32_bf16 v[152:155], a[4:7], a[204:207], v[152:155]
    ds_read_b64 a[42:43], v219 offset:32
    s_waitcnt lgkmcnt(10)
    v_mfma_f32_16x16x32_bf16 v[60:63], a[8:11], a[196:199], v[60:63]
    ds_read_b64 a[44:45], v220 offset:0
    v_mfma_f32_16x16x32_bf16 v[64:67], a[8:11], a[200:203], v[64:67]
    ds_read_b64 a[46:47], v220 offset:32
    v_mfma_f32_16x16x32_bf16 v[68:71], a[8:11], a[204:207], v[68:71]
    ds_read_b64 a[48:49], v221 offset:0
    ds_read_b64 a[50:51], v221 offset:32
    ds_read_b64 a[52:53], v222 offset:0
    ds_read_b64 a[54:55], v222 offset:32
    ds_read_b64 a[56:57], v219 offset:4160
    ds_read_b64 a[58:59], v219 offset:4192
    ds_read_b64 a[60:61], v220 offset:4160
    ds_read_b64 a[62:63], v220 offset:4192
    ds_read_b64 a[64:65], v221 offset:4160
    ds_read_b64 a[66:67], v221 offset:4192
    ds_read_b64 a[68:69], v222 offset:4160
    ds_read_b64 a[70:71], v222 offset:4192
    s_waitcnt vmcnt(13) lgkmcnt(0)
    s_barrier
    v_mfma_f32_16x16x32_bf16 v[156:159], a[12:15], a[196:199], v[156:159]
    ds_read_b64_tr_b16 a[0:1], v192 offset:0
    s_add_u32 s46, s39, 2097152
    v_mfma_f32_16x16x32_bf16 v[160:163], a[12:15], a[200:203], v[160:163]
    ds_read_b64_tr_b16 a[2:3], v192 offset:16384
    s_add_u32 m0, s50, 65536
    v_mfma_f32_16x16x32_bf16 v[164:167], a[12:15], a[204:207], v[164:167]
    ds_read_b64_tr_b16 a[4:5], v193 offset:0
    v_mfma_f32_16x16x32_bf16 v[72:75], a[16:19], a[196:199], v[72:75]
    buffer_load_dwordx4 v208, s[20:23], s46 offen offset:0 lds
    v_mfma_f32_16x16x32_bf16 v[76:79], a[16:19], a[200:203], v[76:79]
    ds_read_b64_tr_b16 a[6:7], v193 offset:16384
    s_add_u32 s44, s40, 640
    v_mfma_f32_16x16x32_bf16 v[80:83], a[16:19], a[204:207], v[80:83]
    buffer_load_dwordx4 v209, s[20:23], s46 offen offset:1024 lds
    v_mfma_f32_16x16x32_bf16 v[168:171], a[20:23], a[196:199], v[168:171]
    ds_read_b64_tr_b16 a[8:9], v194 offset:0
    s_add_u32 s45, s42, 8192
    v_mfma_f32_16x16x32_bf16 v[172:175], a[20:23], a[200:203], v[172:175]
    buffer_load_dwordx4 v210, s[20:23], s46 offen offset:2048 lds
    v_mfma_f32_16x16x32_bf16 v[176:179], a[20:23], a[204:207], v[176:179]
    ds_read_b64_tr_b16 a[10:11], v194 offset:16384
    v_mfma_f32_16x16x32_bf16 v[84:87], a[24:27], a[196:199], v[84:87]
    buffer_load_dwordx4 v211, s[20:23], s46 offen offset:3072 lds
    v_mfma_f32_16x16x32_bf16 v[88:91], a[24:27], a[200:203], v[88:91]
    ds_read_b64_tr_b16 a[12:13], v195 offset:0
    s_add_u32 m0, s50, 69632
    v_mfma_f32_16x16x32_bf16 v[92:95], a[24:27], a[204:207], v[92:95]
    buffer_load_dwordx4 v212, s[20:23], s46 offen offset:0 lds
    v_mfma_f32_16x16x32_bf16 v[180:183], a[28:31], a[196:199], v[180:183]
    ds_read_b64_tr_b16 a[14:15], v195 offset:16384
    s_add_u32 s86, s60, 80
    v_mfma_f32_16x16x32_bf16 v[184:187], a[28:31], a[200:203], v[184:187]
    buffer_load_dwordx4 v213, s[20:23], s46 offen offset:1024 lds
    v_mfma_f32_16x16x32_bf16 v[188:191], a[28:31], a[204:207], v[188:191]
    ds_read_b64_tr_b16 a[16:17], v196 offset:0
    s_waitcnt lgkmcnt(5)
    v_mfma_f32_16x16x32_bf16 v[0:3], a[0:3], a[208:211], v[0:3]
    ds_read_b64_tr_b16 a[18:19], v196 offset:16384
    s_lshr_b32 s86, s86, 7
    v_mfma_f32_16x16x32_bf16 v[4:7], a[0:3], a[212:215], v[4:7]
    buffer_load_dwordx4 v214, s[20:23], s46 offen offset:2048 lds
    v_mfma_f32_16x16x32_bf16 v[8:11], a[0:3], a[216:219], v[8:11]
    ds_read_b64_tr_b16 a[20:21], v197 offset:0
    s_mul_i32 s86, s86, 2147479552
    v_mfma_f32_16x16x32_bf16 v[96:99], a[4:7], a[208:211], v[96:99]
    ds_read_b64_tr_b16 a[22:23], v197 offset:16384
    s_add_u32 s65, s65, s86
    v_mfma_f32_16x16x32_bf16 v[100:103], a[4:7], a[212:215], v[100:103]
    buffer_load_dwordx4 v215, s[20:23], s46 offen offset:3072 lds
    v_mfma_f32_16x16x32_bf16 v[104:107], a[4:7], a[216:219], v[104:107]
    ds_read_b64_tr_b16 a[24:25], v198 offset:0
    s_waitcnt lgkmcnt(5)
    v_mfma_f32_16x16x32_bf16 v[12:15], a[8:11], a[208:211], v[12:15]
    ds_read_b64_tr_b16 a[26:27], v198 offset:16384
    s_add_u32 m0, s41, 12288
    v_mfma_f32_16x16x32_bf16 v[16:19], a[8:11], a[212:215], v[16:19]
    buffer_load_dwordx4 v218, s[8:11], s44 offen lds
    v_mfma_f32_16x16x32_bf16 v[20:23], a[8:11], a[216:219], v[20:23]
    ds_read_b64_tr_b16 a[28:29], v199 offset:0
    s_add_u32 s44, s40, 29312
    v_mfma_f32_16x16x32_bf16 v[108:111], a[12:15], a[208:211], v[108:111]
    ds_read_b64_tr_b16 a[30:31], v199 offset:16384
    s_add_u32 m0, s41, 16384
    v_mfma_f32_16x16x32_bf16 v[112:115], a[12:15], a[212:215], v[112:115]
    buffer_load_dwordx4 v218, s[8:11], s44 offen lds
    v_mfma_f32_16x16x32_bf16 v[116:119], a[12:15], a[216:219], v[116:119]
    ds_read_b64_tr_b16 a[0:1], v192 offset:256
    s_waitcnt lgkmcnt(5)
    v_mfma_f32_16x16x32_bf16 v[24:27], a[16:19], a[208:211], v[24:27]
    ds_read_b64_tr_b16 a[2:3], v192 offset:16640
    s_add_u32 s44, s40, 57984
    v_mfma_f32_16x16x32_bf16 v[28:31], a[16:19], a[212:215], v[28:31]
    ds_read_b64_tr_b16 a[4:5], v193 offset:256
    s_add_u32 m0, s41, 20480
    v_mfma_f32_16x16x32_bf16 v[32:35], a[16:19], a[216:219], v[32:35]
    buffer_load_dwordx4 v218, s[8:11], s44 offen lds
    v_mfma_f32_16x16x32_bf16 v[120:123], a[20:23], a[208:211], v[120:123]
    ds_read_b64_tr_b16 a[6:7], v193 offset:16640
    s_add_u32 m0, s43, 0
    v_mfma_f32_16x16x32_bf16 v[124:127], a[20:23], a[212:215], v[124:127]
    buffer_load_dwordx4 v223, s[12:15], s45 offen offset:0 nt lds
    v_mfma_f32_16x16x32_bf16 v[128:131], a[20:23], a[216:219], v[128:131]
    ds_read_b64_tr_b16 a[8:9], v194 offset:256
    s_waitcnt lgkmcnt(5)
    v_mfma_f32_16x16x32_bf16 v[36:39], a[24:27], a[208:211], v[36:39]
    ds_read_b64_tr_b16 a[10:11], v194 offset:16640
    s_add_u32 s45, s42, 9200
    v_mfma_f32_16x16x32_bf16 v[40:43], a[24:27], a[212:215], v[40:43]
    buffer_load_dwordx4 v223, s[12:15], s45 offen offset:1040 nt lds
    v_mfma_f32_16x16x32_bf16 v[44:47], a[24:27], a[216:219], v[44:47]
    ds_read_b64_tr_b16 a[12:13], v195 offset:256
    s_add_u32 s45, s42, 10208
    v_mfma_f32_16x16x32_bf16 v[132:135], a[28:31], a[208:211], v[132:135]
    ds_read_b64_tr_b16 a[14:15], v195 offset:16640
    s_add_u32 s69, s69, s86
    v_mfma_f32_16x16x32_bf16 v[136:139], a[28:31], a[212:215], v[136:139]
    buffer_load_dwordx4 v223, s[12:15], s45 offen offset:2080 nt lds
    v_mfma_f32_16x16x32_bf16 v[140:143], a[28:31], a[216:219], v[140:143]
    ds_read_b64_tr_b16 a[16:17], v196 offset:256
    s_waitcnt lgkmcnt(5)
    v_mfma_f32_16x16x32_bf16 v[48:51], a[0:3], a[208:211], v[48:51]
    ds_read_b64_tr_b16 a[18:19], v196 offset:16640
    s_add_u32 s45, s42, 11216
    v_mfma_f32_16x16x32_bf16 v[52:55], a[0:3], a[212:215], v[52:55]
    buffer_load_dwordx4 v223, s[12:15], s45 offen offset:3120 nt lds
    v_mfma_f32_16x16x32_bf16 v[56:59], a[0:3], a[216:219], v[56:59]
    ds_read_b64_tr_b16 a[20:21], v197 offset:256
    s_add_u32 m0, s43, 4160
    v_mfma_f32_16x16x32_bf16 v[144:147], a[4:7], a[208:211], v[144:147]
    ds_read_b64_tr_b16 a[22:23], v197 offset:16640
    s_add_u32 s45, s42, 8448
    v_mfma_f32_16x16x32_bf16 v[148:151], a[4:7], a[212:215], v[148:151]
    buffer_load_dwordx4 v223, s[12:15], s45 offen offset:0 nt lds
    v_mfma_f32_16x16x32_bf16 v[152:155], a[4:7], a[216:219], v[152:155]
    ds_read_b64_tr_b16 a[24:25], v198 offset:256
    s_waitcnt lgkmcnt(5)
    v_mfma_f32_16x16x32_bf16 v[60:63], a[8:11], a[208:211], v[60:63]
    ds_read_b64_tr_b16 a[26:27], v198 offset:16640
    s_add_u32 s45, s42, 9456
    v_mfma_f32_16x16x32_bf16 v[64:67], a[8:11], a[212:215], v[64:67]
    buffer_load_dwordx4 v223, s[12:15], s45 offen offset:1040 nt lds
    v_mfma_f32_16x16x32_bf16 v[68:71], a[8:11], a[216:219], v[68:71]
    ds_read_b64_tr_b16 a[28:29], v199 offset:256
    s_add_u32 s45, s42, 10464
    ds_read_b64_tr_b16 a[30:31], v199 offset:16640
    buffer_load_dwordx4 v223, s[12:15], s45 offen offset:2080 nt lds
    s_add_u32 s45, s42, 11472
    buffer_load_dwordx4 v223, s[12:15], s45 offen offset:3120 nt lds
    s_add_u32 s60, s85, 48
    s_mul_i32 s74, s60, 43
    s_lshr_b32 s74, s74, 9
    s_mul_i32 s75, s74, 12
    s_sub_u32 s75, s60, s75
    s_mul_i32 s86, s75, 43
    s_lshr_b32 s86, s86, 8
    s_mul_i32 s87, s86, 6
    s_sub_u32 s75, s75, s87
    s_mul_i32 s66, s74, 6
    s_add_u32 s66, s66, s75
    s_lshl_b32 s66, s66, 10
    s_mul_i32 s87, s86, 43008
    s_add_u32 s66, s66, s87
    s_add_u32 s66, s66, s84
    s_mul_i32 s87, s75, 43
    s_lshr_b32 s87, s87, 7
    s_lshl_b32 s74, s74, 1
    s_add_u32 s74, s74, s87
    s_lshl_b32 s74, s74, 6
    s_mul_i32 s87, s87, 3
    s_sub_u32 s75, s75, s87
    s_add_u32 s86, s86, s37
    s_mul_i32 s86, s86, 3
    s_add_u32 s86, s86, s75
    s_mul_i32 s70, s86, 28672
    s_add_u32 s70, s70, s74
    s_mul_i32 s86, s35, 896
    s_add_u32 s70, s70, s86
    s_add_u32 s60, s85, 80
    s_cmp_lg_u32 s32, 0
    s_cbranch_scc1 L_w0_0
    s_mov_b64 exec, 1
    v_mov_b32 v254, 1
    v_mov_b32 v250, v252
    buffer_atomic_add v254, v253, s[80:83], s72 offen sc0
    s_mov_b64 exec, -1
L_w0_0:
    s_waitcnt vmcnt(19) lgkmcnt(0)
    s_barrier
    v_mfma_f32_16x16x32_bf16 v[156:159], a[12:15], a[208:211], v[156:159]
    ds_read_b64_tr_b16 a[0:1], v192 offset:32768
    s_add_u32 s46, s39, 2359296
    v_mfma_f32_16x16x32_bf16 v[160:163], a[12:15], a[212:215], v[160:163]
    ds_read_b64_tr_b16 a[2:3], v192 offset:49152
    s_add_u32 m0, s50, 0
    v_mfma_f32_16x16x32_bf16 v[164:167], a[12:15], a[216:219], v[164:167]
    ds_read_b64_tr_b16 a[4:5], v193 offset:32768
    v_mfma_f32_16x16x32_bf16 v[72:75], a[16:19], a[208:211], v[72:75]
    buffer_load_dwordx4 v208, s[20:23], s46 offen offset:0 lds
    v_mfma_f32_16x16x32_bf16 v[76:79], a[16:19], a[212:215], v[76:79]
    ds_read_b64_tr_b16 a[6:7], v193 offset:49152
    v_mfma_f32_16x16x32_bf16 v[80:83], a[16:19], a[216:219], v[80:83]
    ds_read_b64_tr_b16 a[8:9], v194 offset:32768
    v_mfma_f32_16x16x32_bf16 v[168:171], a[20:23], a[208:211], v[168:171]
    ds_read_b64_tr_b16 a[10:11], v194 offset:49152
    v_mfma_f32_16x16x32_bf16 v[172:175], a[20:23], a[212:215], v[172:175]
    ds_read_b64_tr_b16 a[12:13], v195 offset:32768
    v_mfma_f32_16x16x32_bf16 v[176:179], a[20:23], a[216:219], v[176:179]
    ds_read_b64_tr_b16 a[14:15], v195 offset:49152
    v_mfma_f32_16x16x32_bf16 v[84:87], a[24:27], a[208:211], v[84:87]
    buffer_load_dwordx4 v209, s[20:23], s46 offen offset:1024 lds
    v_mfma_f32_16x16x32_bf16 v[88:91], a[24:27], a[212:215], v[88:91]
    ds_read_b64_tr_b16 a[16:17], v196 offset:32768
    v_mfma_f32_16x16x32_bf16 v[92:95], a[24:27], a[216:219], v[92:95]
    ds_read_b64_tr_b16 a[18:19], v196 offset:49152
    v_mfma_f32_16x16x32_bf16 v[180:183], a[28:31], a[208:211], v[180:183]
    ds_read_b64_tr_b16 a[20:21], v197 offset:32768
    v_mfma_f32_16x16x32_bf16 v[184:187], a[28:31], a[212:215], v[184:187]
    ds_read_b64_tr_b16 a[22:23], v197 offset:49152
    v_mfma_f32_16x16x32_bf16 v[188:191], a[28:31], a[216:219], v[188:191]
    ds_read_b64_tr_b16 a[24:25], v198 offset:32768
    s_waitcnt lgkmcnt(9)
    v_mfma_f32_16x16x32_bf16 v[0:3], a[0:3], a[220:223], v[0:3]
    buffer_load_dwordx4 v210, s[20:23], s46 offen offset:2048 lds
    v_mfma_f32_16x16x32_bf16 v[4:7], a[0:3], a[224:227], v[4:7]
    ds_read_b64_tr_b16 a[26:27], v198 offset:49152
    v_mfma_f32_16x16x32_bf16 v[8:11], a[0:3], a[228:231], v[8:11]
    ds_read_b64_tr_b16 a[28:29], v199 offset:32768
    v_mfma_f32_16x16x32_bf16 v[96:99], a[4:7], a[220:223], v[96:99]
    ds_read_b64_tr_b16 a[30:31], v199 offset:49152
    v_mfma_f32_16x16x32_bf16 v[100:103], a[4:7], a[224:227], v[100:103]
    ds_read_b64_tr_b16 a[0:1], v192 offset:33024
    v_mfma_f32_16x16x32_bf16 v[104:107], a[4:7], a[228:231], v[104:107]
    ds_read_b64_tr_b16 a[2:3], v192 offset:49408
    s_waitcnt lgkmcnt(10)
    v_mfma_f32_16x16x32_bf16 v[12:15], a[8:11], a[220:223], v[12:15]
    buffer_load_dwordx4 v211, s[20:23], s46 offen offset:3072 lds
    v_mfma_f32_16x16x32_bf16 v[16:19], a[8:11], a[224:227], v[16:19]
    ds_read_b64_tr_b16 a[4:5], v193 offset:33024
    s_add_u32 m0, s50, 4096
    v_mfma_f32_16x16x32_bf16 v[20:23], a[8:11], a[228:231], v[20:23]
    ds_read_b64_tr_b16 a[6:7], v193 offset:49408
    v_mfma_f32_16x16x32_bf16 v[108:111], a[12:15], a[220:223], v[108:111]
    ds_read_b64_tr_b16 a[8:9], v194 offset:33024
    v_mfma_f32_16x16x32_bf16 v[112:115], a[12:15], a[224:227], v[112:115]
    ds_read_b64_tr_b16 a[10:11], v194 offset:49408
    v_mfma_f32_16x16x32_bf16 v[116:119], a[12:15], a[228:231], v[116:119]
    ds_read_b128 a[232:235], v216 offset:0
    s_waitcnt lgkmcnt(11)
    v_mfma_f32_16x16x32_bf16 v[24:27], a[16:19], a[220:223], v[24:27]
    buffer_load_dwordx4 v212, s[20:23], s46 offen offset:0 lds
    v_mfma_f32_16x16x32_bf16 v[28:31], a[16:19], a[224:227], v[28:31]
    ds_read_b64_tr_b16 a[12:13], v195 offset:33024
    v_mfma_f32_16x16x32_bf16 v[32:35], a[16:19], a[228:231], v[32:35]
    ds_read_b64_tr_b16 a[14:15], v195 offset:49408
    v_mfma_f32_16x16x32_bf16 v[120:123], a[20:23], a[220:223], v[120:123]
    ds_read_b64_tr_b16 a[16:17], v196 offset:33024
    v_mfma_f32_16x16x32_bf16 v[124:127], a[20:23], a[224:227], v[124:127]
    ds_read_b64_tr_b16 a[18:19], v196 offset:49408
    v_mfma_f32_16x16x32_bf16 v[128:131], a[20:23], a[228:231], v[128:131]
    ds_read_b128 a[236:239], v216 offset:2048
    s_waitcnt lgkmcnt(12)
    v_mfma_f32_16x16x32_bf16 v[36:39], a[24:27], a[220:223], v[36:39]
    buffer_load_dwordx4 v213, s[20:23], s46 offen offset:1024 lds
    v_mfma_f32_16x16x32_bf16 v[40:43], a[24:27], a[224:227], v[40:43]
    ds_read_b64_tr_b16 a[20:21], v197 offset:33024
    v_mfma_f32_16x16x32_bf16 v[44:47], a[24:27], a[228:231], v[44:47]
    ds_read_b64_tr_b16 a[22:23], v197 offset:49408
    v_mfma_f32_16x16x32_bf16 v[132:135], a[28:31], a[220:223], v[132:135]
    ds_read_b64_tr_b16 a[24:25], v198 offset:33024
    v_mfma_f32_16x16x32_bf16 v[136:139], a[28:31], a[224:227], v[136:139]
    buffer_load_dwordx4 v214, s[20:23], s46 offen offset:2048 lds
    v_mfma_f32_16x16x32_bf16 v[140:143], a[28:31], a[228:231], v[140:143]
    ds_read_b64_tr_b16 a[26:27], v198 offset:49408
    s_waitcnt lgkmcnt(12)
    v_mfma_f32_16x16x32_bf16 v[48:51], a[0:3], a[220:223], v[48:51]
    ds_read_b64_tr_b16 a[28:29], v199 offset:33024
    v_mfma_f32_16x16x32_bf16 v[52:55], a[0:3], a[224:227], v[52:55]
    ds_read_b64_tr_b16 a[30:31], v199 offset:49408
    v_mfma_f32_16x16x32_bf16 v[56:59], a[0:3], a[228:231], v[56:59]
    ds_read_b128 a[240:243], v216 offset:4096
    v_mfma_f32_16x16x32_bf16 v[144:147], a[4:7], a[220:223], v[144:147]
    buffer_load_dwordx4 v215, s[20:23], s46 offen offset:3072 lds
    v_mfma_f32_16x16x32_bf16 v[148:151], a[4:7], a[224:227], v[148:151]
    ds_read_b128 a[244:247], v217 offset:0
    v_mfma_f32_16x16x32_bf16 v[152:155], a[4:7], a[228:231], v[152:155]
    ds_read_b128 a[248:251], v217 offset:2048
    s_waitcnt lgkmcnt(12)
    v_mfma_f32_16x16x32_bf16 v[60:63], a[8:11], a[220:223], v[60:63]
    ds_read_b128 a[252:255], v217 offset:4096
    v_mfma_f32_16x16x32_bf16 v[64:67], a[8:11], a[224:227], v[64:67]
    v_mfma_f32_16x16x32_bf16 v[68:71], a[8:11], a[228:231], v[68:71]
    s_waitcnt vmcnt(16) lgkmcnt(0)
    s_barrier
    v_mfma_f32_16x16x32_bf16 v[156:159], a[12:15], a[220:223], v[156:159]
    ds_read_b64_tr_b16 a[0:1], v200 offset:0
    s_add_u32 s46, s39, 2621440
    v_mfma_f32_16x16x32_bf16 v[160:163], a[12:15], a[224:227], v[160:163]
    ds_read_b64_tr_b16 a[2:3], v200 offset:16384
    s_add_u32 m0, s50, 32768
    v_mfma_f32_16x16x32_bf16 v[164:167], a[12:15], a[228:231], v[164:167]
    ds_read_b64_tr_b16 a[4:5], v201 offset:0
    v_mfma_f32_16x16x32_bf16 v[72:75], a[16:19], a[220:223], v[72:75]
    buffer_load_dwordx4 v208, s[20:23], s46 offen offset:0 lds
    v_mfma_f32_16x16x32_bf16 v[76:79], a[16:19], a[224:227], v[76:79]
    ds_read_b64_tr_b16 a[6:7], v201 offset:16384
    s_add_u32 s44, s40, 768
    v_mfma_f32_16x16x32_bf16 v[80:83], a[16:19], a[228:231], v[80:83]
    ds_read_b64_tr_b16 a[8:9], v202 offset:0
    s_mul_i32 s74, s60, 43
    v_mfma_f32_16x16x32_bf16 v[168:171], a[20:23], a[220:223], v[168:171]
    buffer_load_dwordx4 v209, s[20:23], s46 offen offset:1024 lds
    v_mfma_f32_16x16x32_bf16 v[172:175], a[20:23], a[224:227], v[172:175]
    ds_read_b64_tr_b16 a[10:11], v202 offset:16384
    s_lshr_b32 s74, s74, 9
    v_mfma_f32_16x16x32_bf16 v[176:179], a[20:23], a[228:231], v[176:179]
    ds_read_b64_tr_b16 a[12:13], v203 offset:0
    v_mfma_f32_16x16x32_bf16 v[84:87], a[24:27], a[220:223], v[84:87]
    buffer_load_dwordx4 v210, s[20:23], s46 offen offset:2048 lds
    v_mfma_f32_16x16x32_bf16 v[88:91], a[24:27], a[224:227], v[88:91]
    ds_read_b64_tr_b16 a[14:15], v203 offset:16384
    s_mul_i32 s75, s74, 12
    v_mfma_f32_16x16x32_bf16 v[92:95], a[24:27], a[228:231], v[92:95]
    ds_read_b64_tr_b16 a[16:17], v204 offset:0
    s_sub_u32 s75, s60, s75
    v_mfma_f32_16x16x32_bf16 v[180:183], a[28:31], a[220:223], v[180:183]
    buffer_load_dwordx4 v211, s[20:23], s46 offen offset:3072 lds
    v_mfma_f32_16x16x32_bf16 v[184:187], a[28:31], a[224:227], v[184:187]
    ds_read_b64_tr_b16 a[18:19], v204 offset:16384
    s_add_u32 m0, s50, 36864
    v_mfma_f32_16x16x32_bf16 v[188:191], a[28:31], a[228:231], v[188:191]
    ds_read_b64_tr_b16 a[20:21], v205 offset:0
    s_waitcnt lgkmcnt(7)
    v_mfma_f32_16x16x32_bf16 v[0:3], a[0:3], a[232:235], v[0:3]
    buffer_load_dwordx4 v212, s[20:23], s46 offen offset:0 lds
    v_mfma_f32_16x16x32_bf16 v[4:7], a[0:3], a[236:239], v[4:7]
    ds_read_b64_tr_b16 a[22:23], v205 offset:16384
    s_mul_i32 s86, s75, 43
    v_mfma_f32_16x16x32_bf16 v[8:11], a[0:3], a[240:243], v[8:11]
    ds_read_b64_tr_b16 a[24:25], v206 offset:0
    s_lshr_b32 s86, s86, 8
    v_mfma_f32_16x16x32_bf16 v[96:99], a[4:7], a[232:235], v[96:99]
    ds_read_b64_tr_b16 a[26:27], v206 offset:16384
    s_mul_i32 s87, s86, 6
    v_mfma_f32_16x16x32_bf16 v[100:103], a[4:7], a[236:239], v[100:103]
    buffer_load_dwordx4 v213, s[20:23], s46 offen offset:1024 lds
    v_mfma_f32_16x16x32_bf16 v[104:107], a[4:7], a[240:243], v[104:107]
    ds_read_b64_tr_b16 a[28:29], v207 offset:0
    s_waitcnt lgkmcnt(7)
    v_mfma_f32_16x16x32_bf16 v[12:15], a[8:11], a[232:235], v[12:15]
    ds_read_b64_tr_b16 a[30:31], v207 offset:16384
    s_sub_u32 s75, s75, s87
    v_mfma_f32_16x16x32_bf16 v[16:19], a[8:11], a[236:239], v[16:19]
    ds_read_b64_tr_b16 a[0:1], v200 offset:256
    s_mul_i32 s67, s74, 6
    v_mfma_f32_16x16x32_bf16 v[20:23], a[8:11], a[240:243], v[20:23]
    buffer_load_dwordx4 v214, s[20:23], s46 offen offset:2048 lds
    v_mfma_f32_16x16x32_bf16 v[108:111], a[12:15], a[232:235], v[108:111]
    ds_read_b64_tr_b16 a[2:3], v200 offset:16640
    s_add_u32 s67, s67, s75
    v_mfma_f32_16x16x32_bf16 v[112:115], a[12:15], a[236:239], v[112:115]
    ds_read_b64_tr_b16 a[4:5], v201 offset:256
    s_lshl_b32 s67, s67, 10
    v_mfma_f32_16x16x32_bf16 v[116:119], a[12:15], a[240:243], v[116:119]
    ds_read_b64_tr_b16 a[6:7], v201 offset:16640
    s_waitcnt lgkmcnt(8)
    v_mfma_f32_16x16x32_bf16 v[24:27], a[16:19], a[232:235], v[24:27]
    buffer_load_dwordx4 v215, s[20:23], s46 offen offset:3072 lds
    v_mfma_f32_16x16x32_bf16 v[28:31], a[16:19], a[236:239], v[28:31]
    ds_read_b64_tr_b16 a[8:9], v202 offset:256
    s_add_u32 m0, s41, 0
    v_mfma_f32_16x16x32_bf16 v[32:35], a[16:19], a[240:243], v[32:35]
    ds_read_b64_tr_b16 a[10:11], v202 offset:16640
    s_mul_i32 s87, s86, 43008
    v_mfma_f32_16x16x32_bf16 v[120:123], a[20:23], a[232:235], v[120:123]
    ds_read_b64_tr_b16 a[12:13], v203 offset:256
    s_add_u32 s67, s67, s87
    v_mfma_f32_16x16x32_bf16 v[124:127], a[20:23], a[236:239], v[124:127]
    buffer_load_dwordx4 v218, s[8:11], s44 offen lds
    v_mfma_f32_16x16x32_bf16 v[128:131], a[20:23], a[240:243], v[128:131]
    ds_read_b64_tr_b16 a[14:15], v203 offset:16640
    s_waitcnt lgkmcnt(8)
    v_mfma_f32_16x16x32_bf16 v[36:39], a[24:27], a[232:235], v[36:39]
    ds_read_b64_tr_b16 a[16:17], v204 offset:256
    s_add_u32 s44, s40, 29440
    v_mfma_f32_16x16x32_bf16 v[40:43], a[24:27], a[236:239], v[40:43]
    ds_read_b64_tr_b16 a[18:19], v204 offset:16640
    s_add_u32 m0, s41, 4096
    v_mfma_f32_16x16x32_bf16 v[44:47], a[24:27], a[240:243], v[44:47]
    buffer_load_dwordx4 v218, s[8:11], s44 offen lds
    v_mfma_f32_16x16x32_bf16 v[132:135], a[28:31], a[232:235], v[132:135]
    ds_read_b64_tr_b16 a[20:21], v205 offset:256
    s_add_u32 s44, s40, 58112
    v_mfma_f32_16x16x32_bf16 v[136:139], a[28:31], a[236:239], v[136:139]
    ds_read_b64_tr_b16 a[22:23], v205 offset:16640
    s_add_u32 m0, s41, 8192
    v_mfma_f32_16x16x32_bf16 v[140:143], a[28:31], a[240:243], v[140:143]
    ds_read_b64_tr_b16 a[24:25], v206 offset:256
    s_waitcnt lgkmcnt(9)
    v_mfma_f32_16x16x32_bf16 v[48:51], a[0:3], a[232:235], v[48:51]
    buffer_load_dwordx4 v218, s[8:11], s44 offen lds
    v_mfma_f32_16x16x32_bf16 v[52:55], a[0:3], a[236:239], v[52:55]
    ds_read_b64_tr_b16 a[26:27], v206 offset:16640
    s_add_u32 s67, s67, s84
    v_mfma_f32_16x16x32_bf16 v[56:59], a[0:3], a[240:243], v[56:59]
    ds_read_b64_tr_b16 a[28:29], v207 offset:256
    s_mul_i32 s87, s75, 43
    v_mfma_f32_16x16x32_bf16 v[144:147], a[4:7], a[232:235], v[144:147]
    ds_read_b64_tr_b16 a[30:31], v207 offset:16640
    s_lshr_b32 s87, s87, 7
    v_mfma_f32_16x16x32_bf16 v[148:151], a[4:7], a[236:239], v[148:151]
    ds_read_b128 a[136:139], v216 offset:12288
    s_lshl_b32 s74, s74, 1
    v_mfma_f32_16x16x32_bf16 v[152:155], a[4:7], a[240:243], v[152:155]
    ds_read_b128 a[140:143], v216 offset:14336
    s_waitcnt lgkmcnt(10)
    v_mfma_f32_16x16x32_bf16 v[60:63], a[8:11], a[232:235], v[60:63]
    ds_read_b128 a[144:147], v216 offset:16384
    s_add_u32 s74, s74, s87
    v_mfma_f32_16x16x32_bf16 v[64:67], a[8:11], a[236:239], v[64:67]
    ds_read_b128 a[148:151], v217 offset:12288
    s_lshl_b32 s74, s74, 6
    v_mfma_f32_16x16x32_bf16 v[68:71], a[8:11], a[240:243], v[68:71]
    ds_read_b128 a[152:155], v217 offset:14336
    s_mul_i32 s87, s87, 3
    ds_read_b128 a[156:159], v217 offset:16384
    s_sub_u32 s75, s75, s87
    s_add_u32 s86, s86, s37
    s_mul_i32 s86, s86, 3
    s_add_u32 s86, s86, s75
    s_mul_i32 s71, s86, 28672
    s_add_u32 s71, s71, s74
    s_mul_i32 s86, s35, 896
    s_add_u32 s71, s71, s86
    s_add_u32 s86, s60, 44
    s_lshr_b32 s86, s86, 7
    s_mul_i32 s86, s86, 2147479552
    s_add_u32 s67, s67, s86
    s_add_u32 s71, s71, s86
    s_add_u32 s55, s91, 0
    buffer_load_dword v245, v244, s[24:27], s55 offen
    s_waitcnt vmcnt(12) lgkmcnt(0)
    s_barrier
    v_mfma_f32_16x16x32_bf16 v[156:159], a[12:15], a[232:235], v[156:159]
    ds_read_b64_tr_b16 a[0:1], v192 offset:0
    s_add_u32 s46, s39, 2883584
    v_mfma_f32_16x16x32_bf16 v[160:163], a[12:15], a[236:239], v[160:163]
    ds_read_b64_tr_b16 a[2:3], v192 offset:16384
    s_add_u32 m0, s50, 65536
    v_mfma_f32_16x16x32_bf16 v[164:167], a[12:15], a[240:243], v[164:167]
    ds_read_b64_tr_b16 a[4:5], v193 offset:0
    v_mfma_f32_16x16x32_bf16 v[72:75], a[16:19], a[232:235], v[72:75]
    buffer_load_dwordx4 v208, s[20:23], s46 offen offset:0 lds
    v_mfma_f32_16x16x32_bf16 v[76:79], a[16:19], a[236:239], v[76:79]
    ds_read_b64_tr_b16 a[6:7], v193 offset:16384
    v_mfma_f32_16x16x32_bf16 v[80:83], a[16:19], a[240:243], v[80:83]
    ds_read_b64_tr_b16 a[8:9], v194 offset:0
    v_mfma_f32_16x16x32_bf16 v[168:171], a[20:23], a[232:235], v[168:171]
    ds_read_b64_tr_b16 a[10:11], v194 offset:16384
    v_mfma_f32_16x16x32_bf16 v[172:175], a[20:23], a[236:239], v[172:175]
    ds_read_b64_tr_b16 a[12:13], v195 offset:0
    v_mfma_f32_16x16x32_bf16 v[176:179], a[20:23], a[240:243], v[176:179]
    ds_read_b64_tr_b16 a[14:15], v195 offset:16384
    v_mfma_f32_16x16x32_bf16 v[84:87], a[24:27], a[232:235], v[84:87]
    buffer_load_dwordx4 v209, s[20:23], s46 offen offset:1024 lds
    v_mfma_f32_16x16x32_bf16 v[88:91], a[24:27], a[236:239], v[88:91]
    ds_read_b64_tr_b16 a[16:17], v196 offset:0
    v_mfma_f32_16x16x32_bf16 v[92:95], a[24:27], a[240:243], v[92:95]
    ds_read_b64_tr_b16 a[18:19], v196 offset:16384
    v_mfma_f32_16x16x32_bf16 v[180:183], a[28:31], a[232:235], v[180:183]
    ds_read_b64_tr_b16 a[20:21], v197 offset:0
    v_mfma_f32_16x16x32_bf16 v[184:187], a[28:31], a[236:239], v[184:187]
    ds_read_b64_tr_b16 a[22:23], v197 offset:16384
    v_mfma_f32_16x16x32_bf16 v[188:191], a[28:31], a[240:243], v[188:191]
    ds_read_b64_tr_b16 a[24:25], v198 offset:0
    s_waitcnt lgkmcnt(9)
    v_mfma_f32_16x16x32_bf16 v[0:3], a[0:3], a[244:247], v[0:3]
    buffer_load_dwordx4 v210, s[20:23], s46 offen offset:2048 lds
    v_mfma_f32_16x16x32_bf16 v[4:7], a[0:3], a[248:251], v[4:7]
    ds_read_b64_tr_b16 a[26:27], v198 offset:16384
    v_mfma_f32_16x16x32_bf16 v[8:11], a[0:3], a[252:255], v[8:11]
    ds_read_b64_tr_b16 a[28:29], v199 offset:0
    v_mfma_f32_16x16x32_bf16 v[96:99], a[4:7], a[244:247], v[96:99]
    ds_read_b64_tr_b16 a[30:31], v199 offset:16384
    v_mfma_f32_16x16x32_bf16 v[100:103], a[4:7], a[248:251], v[100:103]
    ds_read_b64_tr_b16 a[0:1], v192 offset:256
    v_mfma_f32_16x16x32_bf16 v[104:107], a[4:7], a[252:255], v[104:107]
    ds_read_b64_tr_b16 a[2:3], v192 offset:16640
    s_waitcnt lgkmcnt(10)
    v_mfma_f32_16x16x32_bf16 v[12:15], a[8:11], a[244:247], v[12:15]
    buffer_load_dwordx4 v211, s[20:23], s46 offen offset:3072 lds
    v_mfma_f32_16x16x32_bf16 v[16:19], a[8:11], a[248:251], v[16:19]
    ds_read_b64_tr_b16 a[4:5], v193 offset:256
    s_add_u32 m0, s50, 69632
    v_mfma_f32_16x16x32_bf16 v[20:23], a[8:11], a[252:255], v[20:23]
    ds_read_b64_tr_b16 a[6:7], v193 offset:16640
    v_mfma_f32_16x16x32_bf16 v[108:111], a[12:15], a[244:247], v[108:111]
    ds_read_b64_tr_b16 a[8:9], v194 offset:256
    v_mfma_f32_16x16x32_bf16 v[112:115], a[12:15], a[248:251], v[112:115]
    ds_read_b64_tr_b16 a[10:11], v194 offset:16640
    v_mfma_f32_16x16x32_bf16 v[116:119], a[12:15], a[252:255], v[116:119]
    ds_read_b64 a[72:73], v219 offset:0
    s_waitcnt lgkmcnt(11)
    v_mfma_f32_16x16x32_bf16 v[24:27], a[16:19], a[244:247], v[24:27]
    buffer_load_dwordx4 v212, s[20:23], s46 offen offset:0 lds
    v_mfma_f32_16x16x32_bf16 v[28:31], a[16:19], a[248:251], v[28:31]
    ds_read_b64_tr_b16 a[12:13], v195 offset:256
    v_mfma_f32_16x16x32_bf16 v[32:35], a[16:19], a[252:255], v[32:35]
    ds_read_b64_tr_b16 a[14:15], v195 offset:16640
    v_mfma_f32_16x16x32_bf16 v[120:123], a[20:23], a[244:247], v[120:123]
    ds_read_b64_tr_b16 a[16:17], v196 offset:256
    v_mfma_f32_16x16x32_bf16 v[124:127], a[20:23], a[248:251], v[124:127]
    ds_read_b64_tr_b16 a[18:19], v196 offset:16640
    v_mfma_f32_16x16x32_bf16 v[128:131], a[20:23], a[252:255], v[128:131]
    ds_read_b64 a[74:75], v219 offset:32
    s_waitcnt lgkmcnt(12)
    v_mfma_f32_16x16x32_bf16 v[36:39], a[24:27], a[244:247], v[36:39]
    buffer_load_dwordx4 v213, s[20:23], s46 offen offset:1024 lds
    v_mfma_f32_16x16x32_bf16 v[40:43], a[24:27], a[248:251], v[40:43]
    ds_read_b64_tr_b16 a[20:21], v197 offset:256
    v_mfma_f32_16x16x32_bf16 v[44:47], a[24:27], a[252:255], v[44:47]
    ds_read_b64_tr_b16 a[22:23], v197 offset:16640
    v_mfma_f32_16x16x32_bf16 v[132:135], a[28:31], a[244:247], v[132:135]
    ds_read_b64_tr_b16 a[24:25], v198 offset:256
    v_mfma_f32_16x16x32_bf16 v[136:139], a[28:31], a[248:251], v[136:139]
    buffer_load_dwordx4 v214, s[20:23], s46 offen offset:2048 lds
    v_mfma_f32_16x16x32_bf16 v[140:143], a[28:31], a[252:255], v[140:143]
    ds_read_b64_tr_b16 a[26:27], v198 offset:16640
    s_waitcnt lgkmcnt(12)
    v_mfma_f32_16x16x32_bf16 v[48:51], a[0:3], a[244:247], v[48:51]
    ds_read_b64_tr_b16 a[28:29], v199 offset:256
    v_mfma_f32_16x16x32_bf16 v[52:55], a[0:3], a[248:251], v[52:55]
    ds_read_b64_tr_b16 a[30:31], v199 offset:16640
    v_mfma_f32_16x16x32_bf16 v[56:59], a[0:3], a[252:255], v[56:59]
    ds_read_b64 a[76:77], v220 offset:0
    v_mfma_f32_16x16x32_bf16 v[144:147], a[4:7], a[244:247], v[144:147]
    buffer_load_dwordx4 v215, s[20:23], s46 offen offset:3072 lds
    v_mfma_f32_16x16x32_bf16 v[148:151], a[4:7], a[248:251], v[148:151]
    ds_read_b64 a[78:79], v220 offset:32
    v_mfma_f32_16x16x32_bf16 v[152:155], a[4:7], a[252:255], v[152:155]
    ds_read_b64 a[80:81], v221 offset:0
    s_waitcnt lgkmcnt(12)
    v_mfma_f32_16x16x32_bf16 v[60:63], a[8:11], a[244:247], v[60:63]
    ds_read_b64 a[82:83], v221 offset:32
    v_mfma_f32_16x16x32_bf16 v[64:67], a[8:11], a[248:251], v[64:67]
    ds_read_b64 a[84:85], v222 offset:0
    v_mfma_f32_16x16x32_bf16 v[68:71], a[8:11], a[252:255], v[68:71]
    ds_read_b64 a[86:87], v222 offset:32
    ds_read_b64 a[88:89], v219 offset:4160
    ds_read_b64 a[90:91], v219 offset:4192
    ds_read_b64 a[92:93], v220 offset:4160
    ds_read_b64 a[94:95], v220 offset:4192
    ds_read_b64 a[96:97], v221 offset:4160
    ds_read_b64 a[98:99], v221 offset:4192
    ds_read_b64 a[100:101], v222 offset:4160
    ds_read_b64 a[102:103], v222 offset:4192
    s_waitcnt vmcnt(9) lgkmcnt(0)
    s_barrier
    s_cmp_lg_u32 s32, 0
    s_cbranch_scc1 L_wp_0
    s_mov_b64 exec, 1
    s_waitcnt vmcnt(28)
    v_readfirstlane_b32 s73, v254
    s_nop 3
    s_and_b32 s73, s73, 7
    s_cmp_lg_u32 s73, 7
    s_cbranch_scc1 L_nl_0
    v_add_u32 v250, 1, v252
    v_mov_b32 v251, 0
    buffer_store_dwordx2 v[250:251], v253, s[4:7], s95 offen sc1
L_nl_0:
    s_mov_b64 exec, -1
L_wp_0:
    v_mfma_f32_16x16x32_bf16 v[156:159], a[12:15], a[244:247], v[156:159]
    ds_read_b64_tr_b16 a[0:1], v192 offset:32768
    s_add_u32 s46, s39, 3145728
    v_mfma_f32_16x16x32_bf16 v[160:163], a[12:15], a[248:251], v[160:163]
    ds_read_b64_tr_b16 a[2:3], v192 offset:49152
    s_add_u32 m0, s50, 0
    v_mfma_f32_16x16x32_bf16 v[164:167], a[12:15], a[252:255], v[164:167]
    ds_read_b64_tr_b16 a[4:5], v193 offset:32768
    v_mfma_f32_16x16x32_bf16 v[72:75], a[16:19], a[244:247], v[72:75]
    buffer_load_dwordx4 v208, s[20:23], s46 offen offset:0 lds
    v_mfma_f32_16x16x32_bf16 v[76:79], a[16:19], a[248:251], v[76:79]
    ds_read_b64_tr_b16 a[6:7], v193 offset:49152
    s_add_u32 s45, s42, 16384
    v_mfma_f32_16x16x32_bf16 v[80:83], a[16:19], a[252:255], v[80:83]
    buffer_load_dwordx4 v209, s[20:23], s46 offen offset:1024 lds
    v_mfma_f32_16x16x32_bf16 v[168:171], a[20:23], a[244:247], v[168:171]
    ds_read_b64_tr_b16 a[8:9], v194 offset:32768
    v_mfma_f32_16x16x32_bf16 v[172:175], a[20:23], a[248:251], v[172:175]
    buffer_load_dwordx4 v210, s[20:23], s46 offen offset:2048 lds
    v_mfma_f32_16x16x32_bf16 v[176:179], a[20:23], a[252:255], v[176:179]
    ds_read_b64_tr_b16 a[10:11], v194 offset:49152
    v_mfma_f32_16x16x32_bf16 v[84:87], a[24:27], a[244:247], v[84:87]
    buffer_load_dwordx4 v211, s[20:23], s46 offen offset:3072 lds
    v_mfma_f32_16x16x32_bf16 v[88:91], a[24:27], a[248:251], v[88:91]
    ds_read_b64_tr_b16 a[12:13], v195 offset:32768
    s_add_u32 m0, s50, 4096
    v_mfma_f32_16x16x32_bf16 v[92:95], a[24:27], a[252:255], v[92:95]
    buffer_load_dwordx4 v212, s[20:23], s46 offen offset:0 lds
    v_mfma_f32_16x16x32_bf16 v[180:183], a[28:31], a[244:247], v[180:183]
    ds_read_b64_tr_b16 a[14:15], v195 offset:49152
    v_mfma_f32_16x16x32_bf16 v[184:187], a[28:31], a[248:251], v[184:187]
    ds_read_b64_tr_b16 a[16:17], v196 offset:32768
    v_mfma_f32_16x16x32_bf16 v[188:191], a[28:31], a[252:255], v[188:191]
    ds_read_b64_tr_b16 a[18:19], v196 offset:49152
    s_waitcnt lgkmcnt(6)
    v_mfma_f32_16x16x32_bf16 v[0:3], a[0:3], a[136:139], v[0:3]
    buffer_load_dwordx4 v213, s[20:23], s46 offen offset:1024 lds
    v_mfma_f32_16x16x32_bf16 v[4:7], a[0:3], a[140:143], v[4:7]
    ds_read_b64_tr_b16 a[20:21], v197 offset:32768
    v_mfma_f32_16x16x32_bf16 v[8:11], a[0:3], a[144:147], v[8:11]
    buffer_load_dwordx4 v214, s[20:23], s46 offen offset:2048 lds
    v_mfma_f32_16x16x32_bf16 v[96:99], a[4:7], a[136:139], v[96:99]
    ds_read_b64_tr_b16 a[22:23], v197 offset:49152
    v_mfma_f32_16x16x32_bf16 v[100:103], a[4:7], a[140:143], v[100:103]
    ds_read_b64_tr_b16 a[24:25], v198 offset:32768
    v_mfma_f32_16x16x32_bf16 v[104:107], a[4:7], a[144:147], v[104:107]
    ds_read_b64_tr_b16 a[26:27], v198 offset:49152
    s_waitcnt lgkmcnt(6)
    v_mfma_f32_16x16x32_bf16 v[12:15], a[8:11], a[136:139], v[12:15]
    buffer_load_dwordx4 v215, s[20:23], s46 offen offset:3072 lds
    v_mfma_f32_16x16x32_bf16 v[16:19], a[8:11], a[140:143], v[16:19]
    ds_read_b64_tr_b16 a[28:29], v199 offset:32768
    s_add_u32 m0, s43, 0
    v_mfma_f32_16x16x32_bf16 v[20:23], a[8:11], a[144:147], v[20:23]
    buffer_load_dwordx4 v223, s[12:15], s45 offen offset:0 nt lds
    v_mfma_f32_16x16x32_bf16 v[108:111], a[12:15], a[136:139], v[108:111]
    ds_read_b64_tr_b16 a[30:31], v199 offset:49152
    s_add_u32 s45, s42, 17392
    v_mfma_f32_16x16x32_bf16 v[112:115], a[12:15], a[140:143], v[112:115]
    ds_read_b64_tr_b16 a[0:1], v192 offset:33024
    v_mfma_f32_16x16x32_bf16 v[116:119], a[12:15], a[144:147], v[116:119]
    ds_read_b64_tr_b16 a[2:3], v192 offset:49408
    s_waitcnt lgkmcnt(6)
    v_mfma_f32_16x16x32_bf16 v[24:27], a[16:19], a[136:139], v[24:27]
    buffer_load_dwordx4 v223, s[12:15], s45 offen offset:1040 nt lds
    v_mfma_f32_16x16x32_bf16 v[28:31], a[16:19], a[140:143], v[28:31]
    ds_read_b64_tr_b16 a[4:5], v193 offset:33024
    s_add_u32 s45, s42, 18400
    v_mfma_f32_16x16x32_bf16 v[32:35], a[16:19], a[144:147], v[32:35]
    buffer_load_dwordx4 v223, s[12:15], s45 offen offset:2080 nt lds
    v_mfma_f32_16x16x32_bf16 v[120:123], a[20:23], a[136:139], v[120:123]
    ds_read_b64_tr_b16 a[6:7], v193 offset:49408
    s_add_u32 s45, s42, 19408
    v_mfma_f32_16x16x32_bf16 v[124:127], a[20:23], a[140:143], v[124:127]
    ds_read_b64_tr_b16 a[8:9], v194 offset:33024
    v_mfma_f32_16x16x32_bf16 v[128:131], a[20:23], a[144:147], v[128:131]
    ds_read_b64_tr_b16 a[10:11], v194 offset:49408
    s_waitcnt lgkmcnt(6)
    v_mfma_f32_16x16x32_bf16 v[36:39], a[24:27], a[136:139], v[36:39]
    buffer_load_dwordx4 v223, s[12:15], s45 offen offset:3120 nt lds
    v_mfma_f32_16x16x32_bf16 v[40:43], a[24:27], a[140:143], v[40:43]
    ds_read_b64_tr_b16 a[12:13], v195 offset:33024
    s_add_u32 m0, s43, 4160
    v_mfma_f32_16x16x32_bf16 v[44:47], a[24:27], a[144:147], v[44:47]
    ds_read_b64_tr_b16 a[14:15], v195 offset:49408
    s_add_u32 s45, s42, 16640
    v_mfma_f32_16x16x32_bf16 v[132:135], a[28:31], a[136:139], v[132:135]
    buffer_load_dwordx4 v223, s[12:15], s45 offen offset:0 nt lds
    v_mfma_f32_16x16x32_bf16 v[136:139], a[28:31], a[140:143], v[136:139]
    ds_read_b64_tr_b16 a[16:17], v196 offset:33024
    s_add_u32 s45, s42, 17648
    v_mfma_f32_16x16x32_bf16 v[140:143], a[28:31], a[144:147], v[140:143]
    ds_read_b64_tr_b16 a[18:19], v196 offset:49408
    s_waitcnt lgkmcnt(6)
    v_mfma_f32_16x16x32_bf16 v[48:51], a[0:3], a[136:139], v[48:51]
    buffer_load_dwordx4 v223, s[12:15], s45 offen offset:1040 nt lds
    v_mfma_f32_16x16x32_bf16 v[52:55], a[0:3], a[140:143], v[52:55]
    ds_read_b64_tr_b16 a[20:21], v197 offset:33024
    s_add_u32 s45, s42, 18656
    v_mfma_f32_16x16x32_bf16 v[56:59], a[0:3], a[144:147], v[56:59]
    buffer_load_dwordx4 v223, s[12:15], s45 offen offset:2080 nt lds
    v_mfma_f32_16x16x32_bf16 v[144:147], a[4:7], a[136:139], v[144:147]
    ds_read_b64_tr_b16 a[22:23], v197 offset:49408
    s_add_u32 s45, s42, 19664
    v_mfma_f32_16x16x32_bf16 v[148:151], a[4:7], a[140:143], v[148:151]
    ds_read_b64_tr_b16 a[24:25], v198 offset:33024
    v_mfma_f32_16x16x32_bf16 v[152:155], a[4:7], a[144:147], v[152:155]
    ds_read_b64_tr_b16 a[26:27], v198 offset:49408
    s_waitcnt lgkmcnt(6)
    v_mfma_f32_16x16x32_bf16 v[60:63], a[8:11], a[136:139], v[60:63]
    buffer_load_dwordx4 v223, s[12:15], s45 offen offset:3120 nt lds
    v_mfma_f32_16x16x32_bf16 v[64:67], a[8:11], a[140:143], v[64:67]
    ds_read_b64_tr_b16 a[28:29], v199 offset:33024
    v_mfma_f32_16x16x32_bf16 v[68:71], a[8:11], a[144:147], v[68:71]
    ds_read_b64_tr_b16 a[30:31], v199 offset:49408
    ds_read_b128 a[160:163], v216 offset:0
    ds_read_b128 a[164:167], v216 offset:2048
    ds_read_b128 a[168:171], v216 offset:4096
    ds_read_b128 a[172:175], v217 offset:0
    ds_read_b128 a[176:179], v217 offset:2048
    ds_read_b128 a[180:183], v217 offset:4096
    s_waitcnt vmcnt(16) lgkmcnt(0)
    s_barrier
    v_mfma_f32_16x16x32_bf16 v[156:159], a[12:15], a[136:139], v[156:159]
    ds_read_b64_tr_b16 a[0:1], v200 offset:0
    s_add_u32 s46, s39, 3407872
    v_mfma_f32_16x16x32_bf16 v[160:163], a[12:15], a[140:143], v[160:163]
    ds_read_b64_tr_b16 a[2:3], v200 offset:16384
    s_add_u32 m0, s50, 32768
    v_mfma_f32_16x16x32_bf16 v[164:167], a[12:15], a[144:147], v[164:167]
    ds_read_b64_tr_b16 a[4:5], v201 offset:0
    v_mfma_f32_16x16x32_bf16 v[72:75], a[16:19], a[136:139], v[72:75]
    buffer_load_dwordx4 v208, s[20:23], s46 offen offset:0 lds
    v_mfma_f32_16x16x32_bf16 v[76:79], a[16:19], a[140:143], v[76:79]
    ds_read_b64_tr_b16 a[6:7], v201 offset:16384
    v_mfma_f32_16x16x32_bf16 v[80:83], a[16:19], a[144:147], v[80:83]
    ds_read_b64_tr_b16 a[8:9], v202 offset:0
    v_mfma_f32_16x16x32_bf16 v[168:171], a[20:23], a[136:139], v[168:171]
    ds_read_b64_tr_b16 a[10:11], v202 offset:16384
    v_mfma_f32_16x16x32_bf16 v[172:175], a[20:23], a[140:143], v[172:175]
    ds_read_b64_tr_b16 a[12:13], v203 offset:0
    v_mfma_f32_16x16x32_bf16 v[176:179], a[20:23], a[144:147], v[176:179]
    ds_read_b64_tr_b16 a[14:15], v203 offset:16384
    v_mfma_f32_16x16x32_bf16 v[84:87], a[24:27], a[136:139], v[84:87]
    buffer_load_dwordx4 v209, s[20:23], s46 offen offset:1024 lds
    v_mfma_f32_16x16x32_bf16 v[88:91], a[24:27], a[140:143], v[88:91]
    ds_read_b64_tr_b16 a[16:17], v204 offset:0
    v_mfma_f32_16x16x32_bf16 v[92:95], a[24:27], a[144:147], v[92:95]
    ds_read_b64_tr_b16 a[18:19], v204 offset:16384
    v_mfma_f32_16x16x32_bf16 v[180:183], a[28:31], a[136:139], v[180:183]
    ds_read_b64_tr_b16 a[20:21], v205 offset:0
    v_mfma_f32_16x16x32_bf16 v[184:187], a[28:31], a[140:143], v[184:187]
    ds_read_b64_tr_b16 a[22:23], v205 offset:16384
    v_mfma_f32_16x16x32_bf16 v[188:191], a[28:31], a[144:147], v[188:191]
    ds_read_b64_tr_b16 a[24:25], v206 offset:0
    s_waitcnt lgkmcnt(9)
    v_mfma_f32_16x16x32_bf16 v[0:3], a[0:3], a[148:151], v[0:3]
    buffer_load_dwordx4 v210, s[20:23], s46 offen offset:2048 lds
    v_mfma_f32_16x16x32_bf16 v[4:7], a[0:3], a[152:155], v[4:7]
    ds_read_b64_tr_b16 a[26:27], v206 offset:16384
    v_mfma_f32_16x16x32_bf16 v[8:11], a[0:3], a[156:159], v[8:11]
    ds_read_b64_tr_b16 a[28:29], v207 offset:0
    v_mfma_f32_16x16x32_bf16 v[96:99], a[4:7], a[148:151], v[96:99]
    ds_read_b64_tr_b16 a[30:31], v207 offset:16384
    v_mfma_f32_16x16x32_bf16 v[100:103], a[4:7], a[152:155], v[100:103]
    ds_read_b64_tr_b16 a[0:1], v200 offset:256
    v_mfma_f32_16x16x32_bf16 v[104:107], a[4:7], a[156:159], v[104:107]
    ds_read_b64_tr_b16 a[2:3], v200 offset:16640
    s_waitcnt lgkmcnt(10)
    v_mfma_f32_16x16x32_bf16 v[12:15], a[8:11], a[148:151], v[12:15]
    buffer_load_dwordx4 v211, s[20:23], s46 offen offset:3072 lds
    v_mfma_f32_16x16x32_bf16 v[16:19], a[8:11], a[152:155], v[16:19]
    ds_read_b64_tr_b16 a[4:5], v201 offset:256
    s_add_u32 m0, s50, 36864
    v_mfma_f32_16x16x32_bf16 v[20:23], a[8:11], a[156:159], v[20:23]
    ds_read_b64_tr_b16 a[6:7], v201 offset:16640
    v_mfma_f32_16x16x32_bf16 v[108:111], a[12:15], a[148:151], v[108:111]
    ds_read_b64_tr_b16 a[8:9], v202 offset:256
    v_mfma_f32_16x16x32_bf16 v[112:115], a[12:15], a[152:155], v[112:115]
    ds_read_b64_tr_b16 a[10:11], v202 offset:16640
    v_mfma_f32_16x16x32_bf16 v[116:119], a[12:15], a[156:159], v[116:119]
    s_waitcnt lgkmcnt(10)
    v_mfma_f32_16x16x32_bf16 v[24:27], a[16:19], a[148:151], v[24:27]
    buffer_load_dwordx4 v212, s[20:23], s46 offen offset:0 lds
    v_mfma_f32_16x16x32_bf16 v[28:31], a[16:19], a[152:155], v[28:31]
    ds_read_b64_tr_b16 a[12:13], v203 offset:256
    v_mfma_f32_16x16x32_bf16 v[32:35], a[16:19], a[156:159], v[32:35]
    ds_read_b64_tr_b16 a[14:15], v203 offset:16640
    v_mfma_f32_16x16x32_bf16 v[120:123], a[20:23], a[148:151], v[120:123]
    ds_read_b64_tr_b16 a[16:17], v204 offset:256
    v_mfma_f32_16x16x32_bf16 v[124:127], a[20:23], a[152:155], v[124:127]
    ds_read_b64_tr_b16 a[18:19], v204 offset:16640
    v_mfma_f32_16x16x32_bf16 v[128:131], a[20:23], a[156:159], v[128:131]
    s_waitcnt lgkmcnt(10)
    v_mfma_f32_16x16x32_bf16 v[36:39], a[24:27], a[148:151], v[36:39]
    buffer_load_dwordx4 v213, s[20:23], s46 offen offset:1024 lds
    v_mfma_f32_16x16x32_bf16 v[40:43], a[24:27], a[152:155], v[40:43]
    ds_read_b64_tr_b16 a[20:21], v205 offset:256
    v_mfma_f32_16x16x32_bf16 v[44:47], a[24:27], a[156:159], v[44:47]
    ds_read_b64_tr_b16 a[22:23], v205 offset:16640
    v_mfma_f32_16x16x32_bf16 v[132:135], a[28:31], a[148:151], v[132:135]
    ds_read_b64_tr_b16 a[24:25], v206 offset:256
    v_mfma_f32_16x16x32_bf16 v[136:139], a[28:31], a[152:155], v[136:139]
    buffer_load_dwordx4 v214, s[20:23], s46 offen offset:2048 lds
    v_mfma_f32_16x16x32_bf16 v[140:143], a[28:31], a[156:159], v[140:143]
    ds_read_b64_tr_b16 a[26:27], v206 offset:16640
    s_waitcnt lgkmcnt(10)
    v_mfma_f32_16x16x32_bf16 v[48:51], a[0:3], a[148:151], v[48:51]
    ds_read_b64_tr_b16 a[28:29], v207 offset:256
    v_mfma_f32_16x16x32_bf16 v[52:55], a[0:3], a[152:155], v[52:55]
    ds_read_b64_tr_b16 a[30:31], v207 offset:16640
    v_mfma_f32_16x16x32_bf16 v[56:59], a[0:3], a[156:159], v[56:59]
    v_mfma_f32_16x16x32_bf16 v[144:147], a[4:7], a[148:151], v[144:147]
    buffer_load_dwordx4 v215, s[20:23], s46 offen offset:3072 lds
    v_mfma_f32_16x16x32_bf16 v[148:151], a[4:7], a[152:155], v[148:151]
    v_mfma_f32_16x16x32_bf16 v[152:155], a[4:7], a[156:159], v[152:155]
    s_waitcnt lgkmcnt(8)
    v_mfma_f32_16x16x32_bf16 v[60:63], a[8:11], a[148:151], v[60:63]
    v_mfma_f32_16x16x32_bf16 v[64:67], a[8:11], a[152:155], v[64:67]
    v_mfma_f32_16x16x32_bf16 v[68:71], a[8:11], a[156:159], v[68:71]
    s_waitcnt vmcnt(16) lgkmcnt(0)
    s_barrier
    v_mfma_f32_16x16x32_bf16 v[156:159], a[12:15], a[148:151], v[156:159]
    ds_read_b64_tr_b16 a[0:1], v192 offset:0
    s_add_u32 s47, s59, 0
    v_mfma_f32_16x16x32_bf16 v[160:163], a[12:15], a[152:155], v[160:163]
    ds_read_b64_tr_b16 a[2:3], v192 offset:16384
    s_add_u32 s48, s59, 28672
    v_mfma_f32_16x16x32_bf16 v[164:167], a[12:15], a[156:159], v[164:167]
    ds_read_b64_tr_b16 a[4:5], v193 offset:0
    v_mfma_f32_16x16x32_bf16 v[72:75], a[16:19], a[148:151], v[72:75]
    ds_read_b64_tr_b16 a[6:7], v193 offset:16384
    s_add_u32 m0, s50, 65536
    v_mfma_f32_16x16x32_bf16 v[76:79], a[16:19], a[152:155], v[76:79]
    buffer_load_dwordx4 v228, s[24:27], s47 offen offset:0 lds
    v_mfma_f32_16x16x32_bf16 v[80:83], a[16:19], a[156:159], v[80:83]
    ds_read_b64_tr_b16 a[8:9], v194 offset:0
    v_mfma_f32_16x16x32_bf16 v[168:171], a[20:23], a[148:151], v[168:171]
    ds_read_b64_tr_b16 a[10:11], v194 offset:16384
    v_mfma_f32_16x16x32_bf16 v[172:175], a[20:23], a[152:155], v[172:175]
    ds_read_b64_tr_b16 a[12:13], v195 offset:0
    v_mfma_f32_16x16x32_bf16 v[176:179], a[20:23], a[156:159], v[176:179]
    ds_read_b64_tr_b16 a[14:15], v195 offset:16384
    v_mfma_f32_16x16x32_bf16 v[84:87], a[24:27], a[148:151], v[84:87]
    buffer_load_dwordx4 v229, s[24:27], s47 offen offset:1024 lds
    v_mfma_f32_16x16x32_bf16 v[88:91], a[24:27], a[152:155], v[88:91]
    ds_read_b64_tr_b16 a[16:17], v196 offset:0
    v_mfma_f32_16x16x32_bf16 v[92:95], a[24:27], a[156:159], v[92:95]
    ds_read_b64_tr_b16 a[18:19], v196 offset:16384
    v_mfma_f32_16x16x32_bf16 v[180:183], a[28:31], a[148:151], v[180:183]
    ds_read_b64_tr_b16 a[20:21], v197 offset:0
    v_mfma_f32_16x16x32_bf16 v[184:187], a[28:31], a[152:155], v[184:187]
    ds_read_b64_tr_b16 a[22:23], v197 offset:16384
    v_mfma_f32_16x16x32_bf16 v[188:191], a[28:31], a[156:159], v[188:191]
    ds_read_b64_tr_b16 a[24:25], v198 offset:0
    s_waitcnt lgkmcnt(9)
    v_mfma_f32_16x16x32_bf16 v[0:3], a[0:3], a[160:163], v[0:3]
    buffer_load_dwordx4 v230, s[24:27], s47 offen offset:2048 lds
    v_mfma_f32_16x16x32_bf16 v[4:7], a[0:3], a[164:167], v[4:7]
    ds_read_b64_tr_b16 a[26:27], v198 offset:16384
    v_mfma_f32_16x16x32_bf16 v[8:11], a[0:3], a[168:171], v[8:11]
    ds_read_b64_tr_b16 a[28:29], v199 offset:0
    v_mfma_f32_16x16x32_bf16 v[96:99], a[4:7], a[160:163], v[96:99]
    ds_read_b64_tr_b16 a[30:31], v199 offset:16384
    v_mfma_f32_16x16x32_bf16 v[100:103], a[4:7], a[164:167], v[100:103]
    ds_read_b64_tr_b16 a[0:1], v192 offset:256
    v_mfma_f32_16x16x32_bf16 v[104:107], a[4:7], a[168:171], v[104:107]
    ds_read_b64_tr_b16 a[2:3], v192 offset:16640
    s_waitcnt lgkmcnt(10)
    v_mfma_f32_16x16x32_bf16 v[12:15], a[8:11], a[160:163], v[12:15]
    buffer_load_dwordx4 v231, s[24:27], s47 offen offset:3072 lds
    v_mfma_f32_16x16x32_bf16 v[16:19], a[8:11], a[164:167], v[16:19]
    ds_read_b64_tr_b16 a[4:5], v193 offset:256
    s_add_u32 m0, s50, 69632
    v_mfma_f32_16x16x32_bf16 v[20:23], a[8:11], a[168:171], v[20:23]
    ds_read_b64_tr_b16 a[6:7], v193 offset:16640
    v_mfma_f32_16x16x32_bf16 v[108:111], a[12:15], a[160:163], v[108:111]
    ds_read_b64_tr_b16 a[8:9], v194 offset:256
    v_mfma_f32_16x16x32_bf16 v[112:115], a[12:15], a[164:167], v[112:115]
    ds_read_b64_tr_b16 a[10:11], v194 offset:16640
    v_mfma_f32_16x16x32_bf16 v[116:119], a[12:15], a[168:171], v[116:119]
    s_waitcnt lgkmcnt(10)
    v_mfma_f32_16x16x32_bf16 v[24:27], a[16:19], a[160:163], v[24:27]
    buffer_load_dwordx4 v228, s[24:27], s48 offen offset:0 lds
    v_mfma_f32_16x16x32_bf16 v[28:31], a[16:19], a[164:167], v[28:31]
    ds_read_b64_tr_b16 a[12:13], v195 offset:256
    v_mfma_f32_16x16x32_bf16 v[32:35], a[16:19], a[168:171], v[32:35]
    ds_read_b64_tr_b16 a[14:15], v195 offset:16640
    v_mfma_f32_16x16x32_bf16 v[120:123], a[20:23], a[160:163], v[120:123]
    ds_read_b64_tr_b16 a[16:17], v196 offset:256
    v_mfma_f32_16x16x32_bf16 v[124:127], a[20:23], a[164:167], v[124:127]
    ds_read_b64_tr_b16 a[18:19], v196 offset:16640
    v_mfma_f32_16x16x32_bf16 v[128:131], a[20:23], a[168:171], v[128:131]
    s_waitcnt lgkmcnt(10)
    v_mfma_f32_16x16x32_bf16 v[36:39], a[24:27], a[160:163], v[36:39]
    buffer_load_dwordx4 v229, s[24:27], s48 offen offset:1024 lds
    v_mfma_f32_16x16x32_bf16 v[40:43], a[24:27], a[164:167], v[40:43]
    ds_read_b64_tr_b16 a[20:21], v197 offset:256
    v_mfma_f32_16x16x32_bf16 v[44:47], a[24:27], a[168:171], v[44:47]
    ds_read_b64_tr_b16 a[22:23], v197 offset:16640
    v_mfma_f32_16x16x32_bf16 v[132:135], a[28:31], a[160:163], v[132:135]
    ds_read_b64_tr_b16 a[24:25], v198 offset:256
    v_mfma_f32_16x16x32_bf16 v[136:139], a[28:31], a[164:167], v[136:139]
    buffer_load_dwordx4 v230, s[24:27], s48 offen offset:2048 lds
    v_mfma_f32_16x16x32_bf16 v[140:143], a[28:31], a[168:171], v[140:143]
    ds_read_b64_tr_b16 a[26:27], v198 offset:16640
    s_waitcnt lgkmcnt(10)
    v_mfma_f32_16x16x32_bf16 v[48:51], a[0:3], a[160:163], v[48:51]
    ds_read_b64_tr_b16 a[28:29], v199 offset:256
    v_mfma_f32_16x16x32_bf16 v[52:55], a[0:3], a[164:167], v[52:55]
    ds_read_b64_tr_b16 a[30:31], v199 offset:16640
    v_mfma_f32_16x16x32_bf16 v[56:59], a[0:3], a[168:171], v[56:59]
    v_mfma_f32_16x16x32_bf16 v[144:147], a[4:7], a[160:163], v[144:147]
    buffer_load_dwordx4 v231, s[24:27], s48 offen offset:3072 lds
    v_mfma_f32_16x16x32_bf16 v[148:151], a[4:7], a[164:167], v[148:151]
    v_mfma_f32_16x16x32_bf16 v[152:155], a[4:7], a[168:171], v[152:155]
    s_waitcnt lgkmcnt(8)
    v_mfma_f32_16x16x32_bf16 v[60:63], a[8:11], a[160:163], v[60:63]
    v_mfma_f32_16x16x32_bf16 v[64:67], a[8:11], a[164:167], v[64:67]
    v_mfma_f32_16x16x32_bf16 v[68:71], a[8:11], a[168:171], v[68:71]
    s_waitcnt vmcnt(8) lgkmcnt(0)
    s_barrier
    v_mfma_f32_16x16x32_bf16 v[156:159], a[12:15], a[160:163], v[156:159]
    ds_read_b64_tr_b16 a[0:1], v192 offset:32768
    s_add_u32 s47, s59, 128
    v_mfma_f32_16x16x32_bf16 v[160:163], a[12:15], a[164:167], v[160:163]
    ds_read_b64_tr_b16 a[2:3], v192 offset:49152
    s_add_u32 s48, s59, 28800
    v_mfma_f32_16x16x32_bf16 v[164:167], a[12:15], a[168:171], v[164:167]
    ds_read_b64_tr_b16 a[4:5], v193 offset:32768
    v_mfma_f32_16x16x32_bf16 v[72:75], a[16:19], a[160:163], v[72:75]
    ds_read_b64_tr_b16 a[6:7], v193 offset:49152
    s_add_u32 m0, s50, 0
    v_mfma_f32_16x16x32_bf16 v[76:79], a[16:19], a[164:167], v[76:79]
    buffer_load_dwordx4 v228, s[24:27], s47 offen offset:0 lds
    v_mfma_f32_16x16x32_bf16 v[80:83], a[16:19], a[168:171], v[80:83]
    ds_read_b64_tr_b16 a[8:9], v194 offset:32768
    s_add_u32 s49, s58, 0
    v_mfma_f32_16x16x32_bf16 v[168:171], a[20:23], a[160:163], v[168:171]
    buffer_load_dwordx4 v229, s[24:27], s47 offen offset:1024 lds
    v_mfma_f32_16x16x32_bf16 v[172:175], a[20:23], a[164:167], v[172:175]
    ds_read_b64_tr_b16 a[10:11], v194 offset:49152
    v_mfma_f32_16x16x32_bf16 v[176:179], a[20:23], a[168:171], v[176:179]
    ds_read_b64_tr_b16 a[12:13], v195 offset:32768
    v_mfma_f32_16x16x32_bf16 v[84:87], a[24:27], a[160:163], v[84:87]
    buffer_load_dwordx4 v230, s[24:27], s47 offen offset:2048 lds
    v_mfma_f32_16x16x32_bf16 v[88:91], a[24:27], a[164:167], v[88:91]
    ds_read_b64_tr_b16 a[14:15], v195 offset:49152
    v_mfma_f32_16x16x32_bf16 v[92:95], a[24:27], a[168:171], v[92:95]
    buffer_load_dwordx4 v231, s[24:27], s47 offen offset:3072 lds
    v_mfma_f32_16x16x32_bf16 v[180:183], a[28:31], a[160:163], v[180:183]
    ds_read_b64_tr_b16 a[16:17], v196 offset:32768
    s_add_u32 m0, s50, 4096
    v_mfma_f32_16x16x32_bf16 v[184:187], a[28:31], a[164:167], v[184:187]
    ds_read_b64_tr_b16 a[18:19], v196 offset:49152
    v_mfma_f32_16x16x32_bf16 v[188:191], a[28:31], a[168:171], v[188:191]
    ds_read_b64_tr_b16 a[20:21], v197 offset:32768
    s_waitcnt lgkmcnt(7)
    v_mfma_f32_16x16x32_bf16 v[0:3], a[0:3], a[172:175], v[0:3]
    buffer_load_dwordx4 v228, s[24:27], s48 offen offset:0 lds
    v_mfma_f32_16x16x32_bf16 v[4:7], a[0:3], a[176:179], v[4:7]
    ds_read_b64_tr_b16 a[22:23], v197 offset:49152
    v_mfma_f32_16x16x32_bf16 v[8:11], a[0:3], a[180:183], v[8:11]
    buffer_load_dwordx4 v229, s[24:27], s48 offen offset:1024 lds
    v_mfma_f32_16x16x32_bf16 v[96:99], a[4:7], a[172:175], v[96:99]
    ds_read_b64_tr_b16 a[24:25], v198 offset:32768
    v_mfma_f32_16x16x32_bf16 v[100:103], a[4:7], a[176:179], v[100:103]
    ds_read_b64_tr_b16 a[26:27], v198 offset:49152
    v_mfma_f32_16x16x32_bf16 v[104:107], a[4:7], a[180:183], v[104:107]
    ds_read_b64_tr_b16 a[28:29], v199 offset:32768
    s_waitcnt lgkmcnt(7)
    v_mfma_f32_16x16x32_bf16 v[12:15], a[8:11], a[172:175], v[12:15]
    buffer_load_dwordx4 v230, s[24:27], s48 offen offset:2048 lds
    v_mfma_f32_16x16x32_bf16 v[16:19], a[8:11], a[176:179], v[16:19]
    ds_read_b64_tr_b16 a[30:31], v199 offset:49152
    v_mfma_f32_16x16x32_bf16 v[20:23], a[8:11], a[180:183], v[20:23]
    buffer_load_dwordx4 v231, s[24:27], s48 offen offset:3072 lds
    v_mfma_f32_16x16x32_bf16 v[108:111], a[12:15], a[172:175], v[108:111]
    ds_read_b64_tr_b16 a[0:1], v192 offset:33024
    s_add_u32 m0, s51, 0
    v_mfma_f32_16x16x32_bf16 v[112:115], a[12:15], a[176:179], v[112:115]
    ds_read_b64_tr_b16 a[2:3], v192 offset:49408
    v_mfma_f32_16x16x32_bf16 v[116:119], a[12:15], a[180:183], v[116:119]
    ds_read_b64_tr_b16 a[4:5], v193 offset:33024
    s_waitcnt lgkmcnt(7)
    v_mfma_f32_16x16x32_bf16 v[24:27], a[16:19], a[172:175], v[24:27]
    buffer_load_dwordx4 v232, s[16:19], s49 offen nt lds
    v_mfma_f32_16x16x32_bf16 v[28:31], a[16:19], a[176:179], v[28:31]
    ds_read_b64_tr_b16 a[6:7], v193 offset:49408
    s_add_u32 s49, s58, 256
    v_mfma_f32_16x16x32_bf16 v[32:35], a[16:19], a[180:183], v[32:35]
    ds_read_b64_tr_b16 a[8:9], v194 offset:33024
    s_add_u32 m0, s51, 4096
    v_mfma_f32_16x16x32_bf16 v[120:123], a[20:23], a[172:175], v[120:123]
    buffer_load_dwordx4 v232, s[16:19], s49 offen nt lds
    v_mfma_f32_16x16x32_bf16 v[124:127], a[20:23], a[176:179], v[124:127]
    ds_read_b64_tr_b16 a[10:11], v194 offset:49408
    s_add_u32 s49, s58, 8192
    v_mfma_f32_16x16x32_bf16 v[128:131], a[20:23], a[180:183], v[128:131]
    ds_read_b64_tr_b16 a[12:13], v195 offset:33024
    s_waitcnt lgkmcnt(7)
    v_mfma_f32_16x16x32_bf16 v[36:39], a[24:27], a[172:175], v[36:39]
    ds_read_b64_tr_b16 a[14:15], v195 offset:49408
    s_add_u32 m0, s51, 8192
    v_mfma_f32_16x16x32_bf16 v[40:43], a[24:27], a[176:179], v[40:43]
    buffer_load_dwordx4 v232, s[16:19], s49 offen nt lds
    v_mfma_f32_16x16x32_bf16 v[44:47], a[24:27], a[180:183], v[44:47]
    ds_read_b64_tr_b16 a[16:17], v196 offset:33024
    s_add_u32 s49, s58, 8448
    v_mfma_f32_16x16x32_bf16 v[132:135], a[28:31], a[172:175], v[132:135]
    ds_read_b64_tr_b16 a[18:19], v196 offset:49408
    s_add_u32 m0, s51, 12288
    v_mfma_f32_16x16x32_bf16 v[136:139], a[28:31], a[176:179], v[136:139]
    buffer_load_dwordx4 v232, s[16:19], s49 offen nt lds
    v_mfma_f32_16x16x32_bf16 v[140:143], a[28:31], a[180:183], v[140:143]
    ds_read_b64_tr_b16 a[20:21], v197 offset:33024
    s_waitcnt lgkmcnt(7)
    v_mfma_f32_16x16x32_bf16 v[48:51], a[0:3], a[172:175], v[48:51]
    ds_read_b64_tr_b16 a[22:23], v197 offset:49408
    s_add_u32 s49, s58, 16384
    v_mfma_f32_16x16x32_bf16 v[52:55], a[0:3], a[176:179], v[52:55]
    ds_read_b64_tr_b16 a[24:25], v198 offset:33024
    s_add_u32 m0, s51, 16384
    v_mfma_f32_16x16x32_bf16 v[56:59], a[0:3], a[180:183], v[56:59]
    buffer_load_dwordx4 v232, s[16:19], s49 offen nt lds
    v_mfma_f32_16x16x32_bf16 v[144:147], a[4:7], a[172:175], v[144:147]
    ds_read_b64_tr_b16 a[26:27], v198 offset:49408
    s_add_u32 s49, s58, 16640
    v_mfma_f32_16x16x32_bf16 v[148:151], a[4:7], a[176:179], v[148:151]
    ds_read_b64_tr_b16 a[28:29], v199 offset:33024
    s_add_u32 m0, s51, 20480
    v_mfma_f32_16x16x32_bf16 v[152:155], a[4:7], a[180:183], v[152:155]
    ds_read_b64_tr_b16 a[30:31], v199 offset:49408
    s_waitcnt lgkmcnt(8)
    v_mfma_f32_16x16x32_bf16 v[60:63], a[8:11], a[172:175], v[60:63]
    buffer_load_dwordx4 v232, s[16:19], s49 offen nt lds
    v_mfma_f32_16x16x32_bf16 v[64:67], a[8:11], a[176:179], v[64:67]
    ds_read_b64 a[104:105], v219 offset:0
    s_add_u32 s49, s58, 393216
    v_mfma_f32_16x16x32_bf16 v[68:71], a[8:11], a[180:183], v[68:71]
    ds_read_b64 a[106:107], v219 offset:32
    s_add_u32 m0, s51, 24576
    ds_read_b64 a[108:109], v220 offset:0
    ds_read_b64 a[110:111], v220 offset:32
    ds_read_b64 a[112:113], v221 offset:0
    ds_read_b64 a[114:115], v221 offset:32
    ds_read_b64 a[116:117], v222 offset:0
    ds_read_b64 a[118:119], v222 offset:32
    ds_read_b64 a[120:121], v219 offset:4160
    ds_read_b64 a[122:123], v219 offset:4192
    ds_read_b64 a[124:125], v220 offset:4160
    ds_read_b64 a[126:127], v220 offset:4192
    ds_read_b64 a[128:129], v221 offset:4160
    ds_read_b64 a[130:131], v221 offset:4192
    ds_read_b64 a[132:133], v222 offset:4160
    ds_read_b64 a[134:135], v222 offset:4192
    buffer_load_dwordx4 v232, s[16:19], s49 offen nt lds
    s_waitcnt lgkmcnt(0)
    s_barrier
    v_mfma_f32_16x16x32_bf16 v[156:159], a[12:15], a[172:175], v[156:159]
    v_cvt_pk_bf16_f32 v0, v0, v1
    v_cvt_pk_bf16_f32 v1, v2, v3
    v_mfma_f32_16x16x32_bf16 v[160:163], a[12:15], a[176:179], v[160:163]
    v_cvt_pk_bf16_f32 v2, v96, v97
    v_cvt_pk_bf16_f32 v3, v98, v99
    v_mfma_f32_16x16x32_bf16 v[164:167], a[12:15], a[180:183], v[164:167]
    v_cvt_pk_bf16_f32 v4, v4, v5
    v_mfma_f32_16x16x32_bf16 v[72:75], a[16:19], a[172:175], v[72:75]
    v_cvt_pk_bf16_f32 v5, v6, v7
    v_cvt_pk_bf16_f32 v6, v100, v101
    v_mfma_f32_16x16x32_bf16 v[76:79], a[16:19], a[176:179], v[76:79]
    v_cvt_pk_bf16_f32 v7, v102, v103
    v_cvt_pk_bf16_f32 v8, v8, v9
    v_mfma_f32_16x16x32_bf16 v[80:83], a[16:19], a[180:183], v[80:83]
    v_cvt_pk_bf16_f32 v9, v10, v11
    v_cvt_pk_bf16_f32 v10, v104, v105
    v_mfma_f32_16x16x32_bf16 v[168:171], a[20:23], a[172:175], v[168:171]
    v_cvt_pk_bf16_f32 v11, v106, v107
    v_cvt_pk_bf16_f32 v12, v12, v13
    v_mfma_f32_16x16x32_bf16 v[172:175], a[20:23], a[176:179], v[172:175]
    v_cvt_pk_bf16_f32 v13, v14, v15
    v_cvt_pk_bf16_f32 v14, v108, v109
    v_mfma_f32_16x16x32_bf16 v[176:179], a[20:23], a[180:183], v[176:179]
    v_cvt_pk_bf16_f32 v15, v110, v111
    v_mfma_f32_16x16x32_bf16 v[84:87], a[24:27], a[172:175], v[84:87]
    v_cvt_pk_bf16_f32 v16, v16, v17
    v_cvt_pk_bf16_f32 v17, v18, v19
    v_mfma_f32_16x16x32_bf16 v[88:91], a[24:27], a[176:179], v[88:91]
    v_cvt_pk_bf16_f32 v18, v112, v113
    v_cvt_pk_bf16_f32 v19, v114, v115
    v_mfma_f32_16x16x32_bf16 v[92:95], a[24:27], a[180:183], v[92:95]
    v_cvt_pk_bf16_f32 v20, v20, v21
    v_cvt_pk_bf16_f32 v21, v22, v23
    v_mfma_f32_16x16x32_bf16 v[180:183], a[28:31], a[172:175], v[180:183]
    v_cvt_pk_bf16_f32 v22, v116, v117
    v_cvt_pk_bf16_f32 v23, v118, v119
    v_mfma_f32_16x16x32_bf16 v[184:187], a[28:31], a[176:179], v[184:187]
    v_cvt_pk_bf16_f32 v24, v24, v25
    v_cvt_pk_bf16_f32 v25, v26, v27
    v_mfma_f32_16x16x32_bf16 v[188:191], a[28:31], a[180:183], v[188:191]
    v_cvt_pk_bf16_f32 v26, v120, v121
    v_cvt_pk_bf16_f32 v27, v122, v123
    v_mfma_f32_16x16x32_bf16 v[192:195], a[40:43], v[0:3], 0
    s_add_u32 s47, s59, 256
    s_add_u32 s48, s59, 28928
    v_mfma_f32_16x16x32_bf16 v[196:199], a[72:75], v[0:3], 0
    s_add_u32 m0, s50, 32768
    s_add_u32 s49, s58, 393472
    v_mfma_f32_16x16x32_bf16 v[200:203], a[104:107], v[0:3], 0
    v_cvt_pk_bf16_f32 v36, v36, v37
    v_cvt_pk_bf16_f32 v37, v38, v39
    v_mfma_f32_16x16x32_bf16 v[192:195], a[44:47], v[12:15], v[192:195]
    buffer_load_dwordx4 v228, s[24:27], s47 offen offset:0 lds
    v_mfma_f32_16x16x32_bf16 v[196:199], a[76:79], v[12:15], v[196:199]
    v_cvt_pk_bf16_f32 v38, v132, v133
    v_cvt_pk_bf16_f32 v39, v134, v135
    v_mfma_f32_16x16x32_bf16 v[200:203], a[108:111], v[12:15], v[200:203]
    v_cvt_pk_bf16_f32 v48, v48, v49
    v_cvt_pk_bf16_f32 v49, v50, v51
    v_mfma_f32_16x16x32_bf16 v[192:195], a[48:51], v[24:27], v[192:195]
    v_cvt_pk_bf16_f32 v50, v144, v145
    v_cvt_pk_bf16_f32 v51, v146, v147
    v_mfma_f32_16x16x32_bf16 v[196:199], a[80:83], v[24:27], v[196:199]
    buffer_load_dwordx4 v229, s[24:27], s47 offen offset:1024 lds
    v_mfma_f32_16x16x32_bf16 v[200:203], a[112:115], v[24:27], v[200:203]
    v_cvt_pk_bf16_f32 v60, v60, v61
    v_cvt_pk_bf16_f32 v61, v62, v63
    v_mfma_f32_16x16x32_bf16 v[192:195], a[52:55], v[36:39], v[192:195]
    v_cvt_pk_bf16_f32 v62, v156, v157
    v_cvt_pk_bf16_f32 v63, v158, v159
    v_mfma_f32_16x16x32_bf16 v[196:199], a[84:87], v[36:39], v[196:199]
    v_cvt_pk_bf16_f32 v72, v72, v73
    v_cvt_pk_bf16_f32 v73, v74, v75
    v_mfma_f32_16x16x32_bf16 v[200:203], a[116:119], v[36:39], v[200:203]
    buffer_load_dwordx4 v230, s[24:27], s47 offen offset:2048 lds
    v_mfma_f32_16x16x32_bf16 v[192:195], a[56:59], v[48:51], v[192:195]
    v_cvt_pk_bf16_f32 v74, v168, v169
    v_cvt_pk_bf16_f32 v75, v170, v171
    v_mfma_f32_16x16x32_bf16 v[196:199], a[88:91], v[48:51], v[196:199]
    v_cvt_pk_bf16_f32 v84, v84, v85
    v_cvt_pk_bf16_f32 v85, v86, v87
    v_mfma_f32_16x16x32_bf16 v[200:203], a[120:123], v[48:51], v[200:203]
    v_cvt_pk_bf16_f32 v86, v180, v181
    v_cvt_pk_bf16_f32 v87, v182, v183
    v_mfma_f32_16x16x32_bf16 v[192:195], a[60:63], v[60:63], v[192:195]
    buffer_load_dwordx4 v231, s[24:27], s47 offen offset:3072 lds
    v_mfma_f32_16x16x32_bf16 v[196:199], a[92:95], v[60:63], v[196:199]
    s_add_u32 m0, s50, 36864
    v_cvt_pk_bf16_f32 v28, v28, v29
    v_mfma_f32_16x16x32_bf16 v[200:203], a[124:127], v[60:63], v[200:203]
    v_cvt_pk_bf16_f32 v29, v30, v31
    v_cvt_pk_bf16_f32 v30, v124, v125
    v_mfma_f32_16x16x32_bf16 v[192:195], a[64:67], v[72:75], v[192:195]
    v_cvt_pk_bf16_f32 v31, v126, v127
    v_cvt_pk_bf16_f32 v40, v40, v41
    v_mfma_f32_16x16x32_bf16 v[196:199], a[96:99], v[72:75], v[196:199]
    buffer_load_dwordx4 v228, s[24:27], s48 offen offset:0 lds
    v_mfma_f32_16x16x32_bf16 v[200:203], a[128:131], v[72:75], v[200:203]
    v_cvt_pk_bf16_f32 v41, v42, v43
    v_cvt_pk_bf16_f32 v42, v136, v137
    v_mfma_f32_16x16x32_bf16 v[192:195], a[68:71], v[84:87], v[192:195]
    v_cvt_pk_bf16_f32 v43, v138, v139
    v_cvt_pk_bf16_f32 v52, v52, v53
    v_mfma_f32_16x16x32_bf16 v[196:199], a[100:103], v[84:87], v[196:199]
    v_cvt_pk_bf16_f32 v53, v54, v55
    v_cvt_pk_bf16_f32 v54, v148, v149
    v_mfma_f32_16x16x32_bf16 v[200:203], a[132:135], v[84:87], v[200:203]
    buffer_load_dwordx4 v229, s[24:27], s48 offen offset:1024 lds
    v_mfma_f32_16x16x32_bf16 v[204:207], a[40:43], v[4:7], 0
    v_cvt_pk_bf16_f32 v55, v150, v151
    v_cvt_pk_bf16_f32 v64, v64, v65
    v_mfma_f32_16x16x32_bf16 v[208:211], a[72:75], v[4:7], 0
    v_cvt_pk_bf16_f32 v65, v66, v67
    v_cvt_pk_bf16_f32 v66, v160, v161
    v_mfma_f32_16x16x32_bf16 v[212:215], a[104:107], v[4:7], 0
    v_cvt_pk_bf16_f32 v67, v162, v163
    v_cvt_pk_bf16_f32 v76, v76, v77
    v_mfma_f32_16x16x32_bf16 v[204:207], a[44:47], v[16:19], v[204:207]
    buffer_load_dwordx4 v230, s[24:27], s48 offen offset:2048 lds
    v_mfma_f32_16x16x32_bf16 v[208:211], a[76:79], v[16:19], v[208:211]
    v_cvt_pk_bf16_f32 v77, v78, v79
    v_cvt_pk_bf16_f32 v78, v172, v173
    v_mfma_f32_16x16x32_bf16 v[212:215], a[108:111], v[16:19], v[212:215]
    v_cvt_pk_bf16_f32 v79, v174, v175
    v_cvt_pk_bf16_f32 v88, v88, v89
    v_mfma_f32_16x16x32_bf16 v[204:207], a[48:51], v[28:31], v[204:207]
    v_cvt_pk_bf16_f32 v89, v90, v91
    v_cvt_pk_bf16_f32 v90, v184, v185
    v_mfma_f32_16x16x32_bf16 v[208:211], a[80:83], v[28:31], v[208:211]
    buffer_load_dwordx4 v231, s[24:27], s48 offen offset:3072 lds
    v_mfma_f32_16x16x32_bf16 v[212:215], a[112:115], v[28:31], v[212:215]
    s_add_u32 m0, s51, 28672
    v_cvt_pk_bf16_f32 v91, v186, v187
    v_mfma_f32_16x16x32_bf16 v[204:207], a[52:55], v[40:43], v[204:207]
    v_cvt_pk_bf16_f32 v32, v32, v33
    v_cvt_pk_bf16_f32 v33, v34, v35
    v_mfma_f32_16x16x32_bf16 v[208:211], a[84:87], v[40:43], v[208:211]
    v_cvt_pk_bf16_f32 v34, v128, v129
    v_cvt_pk_bf16_f32 v35, v130, v131
    v_mfma_f32_16x16x32_bf16 v[212:215], a[116:119], v[40:43], v[212:215]
    buffer_load_dwordx4 v232, s[16:19], s49 offen nt lds
    v_mfma_f32_16x16x32_bf16 v[204:207], a[56:59], v[52:55], v[204:207]
    s_add_u32 s49, s58, 401408
    s_add_u32 m0, s51, 32768
    v_mfma_f32_16x16x32_bf16 v[208:211], a[88:91], v[52:55], v[208:211]
    v_cvt_pk_bf16_f32 v44, v44, v45
    v_cvt_pk_bf16_f32 v45, v46, v47
    v_mfma_f32_16x16x32_bf16 v[212:215], a[120:123], v[52:55], v[212:215]
    v_cvt_pk_bf16_f32 v46, v140, v141
    v_cvt_pk_bf16_f32 v47, v142, v143
    v_mfma_f32_16x16x32_bf16 v[204:207], a[60:63], v[64:67], v[204:207]
    buffer_load_dwordx4 v232, s[16:19], s49 offen nt lds
    v_mfma_f32_16x16x32_bf16 v[208:211], a[92:95], v[64:67], v[208:211]
    s_add_u32 s49, s58, 401664
    s_add_u32 m0, s51, 36864
    v_mfma_f32_16x16x32_bf16 v[212:215], a[124:127], v[64:67], v[212:215]
    v_cvt_pk_bf16_f32 v56, v56, v57
    v_cvt_pk_bf16_f32 v57, v58, v59
    v_mfma_f32_16x16x32_bf16 v[204:207], a[64:67], v[76:79], v[204:207]
    v_cvt_pk_bf16_f32 v58, v152, v153
    v_cvt_pk_bf16_f32 v59, v154, v155
    v_mfma_f32_16x16x32_bf16 v[208:211], a[96:99], v[76:79], v[208:211]
    buffer_load_dwordx4 v232, s[16:19], s49 offen nt lds
    v_mfma_f32_16x16x32_bf16 v[212:215], a[128:131], v[76:79], v[212:215]
    s_add_u32 s49, s58, 409600
    s_add_u32 m0, s51, 40960
    v_mfma_f32_16x16x32_bf16 v[204:207], a[68:71], v[88:91], v[204:207]
    v_cvt_pk_bf16_f32 v68, v68, v69
    v_cvt_pk_bf16_f32 v69, v70, v71
    v_mfma_f32_16x16x32_bf16 v[208:211], a[100:103], v[88:91], v[208:211]
    v_cvt_pk_bf16_f32 v70, v164, v165
    v_cvt_pk_bf16_f32 v71, v166, v167
    v_mfma_f32_16x16x32_bf16 v[212:215], a[132:135], v[88:91], v[212:215]
    buffer_load_dwordx4 v232, s[16:19], s49 offen nt lds
    v_mfma_f32_16x16x32_bf16 v[216:219], a[40:43], v[8:11], 0
    s_add_u32 s49, s58, 409856
    s_add_u32 m0, s51, 45056
    v_mfma_f32_16x16x32_bf16 v[220:223], a[72:75], v[8:11], 0
    v_cvt_pk_bf16_f32 v80, v80, v81
    v_cvt_pk_bf16_f32 v81, v82, v83
    v_mfma_f32_16x16x32_bf16 v[224:227], a[104:107], v[8:11], 0
    v_cvt_pk_bf16_f32 v82, v176, v177
    v_cvt_pk_bf16_f32 v83, v178, v179
    v_mfma_f32_16x16x32_bf16 v[216:219], a[44:47], v[20:23], v[216:219]
    buffer_load_dwordx4 v232, s[16:19], s49 offen nt lds
    v_mfma_f32_16x16x32_bf16 v[220:223], a[76:79], v[20:23], v[220:223]
    v_cvt_pk_bf16_f32 v92, v92, v93
    v_cvt_pk_bf16_f32 v93, v94, v95
    v_mfma_f32_16x16x32_bf16 v[224:227], a[108:111], v[20:23], v[224:227]
    v_cvt_pk_bf16_f32 v94, v188, v189
    v_cvt_pk_bf16_f32 v95, v190, v191
    v_mfma_f32_16x16x32_bf16 v[216:219], a[48:51], v[32:35], v[216:219]
    v_cvt_pk_bf16_f32 v246, v192, v193
    v_lshlrev_b32 v192, 16, v246
    v_mfma_f32_16x16x32_bf16 v[220:223], a[80:83], v[32:35], v[220:223]
    v_and_b32 v193, 0xffff0000, v246
    v_cvt_pk_bf16_f32 v247, v194, v195
    v_mfma_f32_16x16x32_bf16 v[224:227], a[112:115], v[32:35], v[224:227]
    v_lshlrev_b32 v194, 16, v247
    v_and_b32 v195, 0xffff0000, v247
    v_mfma_f32_16x16x32_bf16 v[216:219], a[52:55], v[44:47], v[216:219]
    v_cvt_pk_bf16_f32 v246, v196, v197
    v_lshlrev_b32 v196, 16, v246
    v_mfma_f32_16x16x32_bf16 v[220:223], a[84:87], v[44:47], v[220:223]
    v_and_b32 v197, 0xffff0000, v246
    v_cvt_pk_bf16_f32 v247, v198, v199
    v_mfma_f32_16x16x32_bf16 v[224:227], a[116:119], v[44:47], v[224:227]
    v_lshlrev_b32 v198, 16, v247
    v_and_b32 v199, 0xffff0000, v247
    v_mfma_f32_16x16x32_bf16 v[216:219], a[56:59], v[56:59], v[216:219]
    v_cvt_pk_bf16_f32 v246, v200, v201
    v_lshlrev_b32 v200, 16, v246
    v_mfma_f32_16x16x32_bf16 v[220:223], a[88:91], v[56:59], v[220:223]
    v_and_b32 v201, 0xffff0000, v246
    v_cvt_pk_bf16_f32 v247, v202, v203
    v_mfma_f32_16x16x32_bf16 v[224:227], a[120:123], v[56:59], v[224:227]
    v_lshlrev_b32 v202, 16, v247
    v_and_b32 v203, 0xffff0000, v247
    v_mfma_f32_16x16x32_bf16 v[216:219], a[60:63], v[68:71], v[216:219]
    v_max3_f32 v246, v192, v193, v194
    v_max3_f32 v247, v195, v196, v197
    v_mfma_f32_16x16x32_bf16 v[220:223], a[92:95], v[68:71], v[220:223]
    v_max3_f32 v246, v246, v198, v199
    v_max3_f32 v247, v247, v200, v201
    v_mfma_f32_16x16x32_bf16 v[224:227], a[124:127], v[68:71], v[224:227]
    v_max3_f32 v246, v246, v202, v203
    v_max_f32 v246, v246, v247
    v_mfma_f32_16x16x32_bf16 v[216:219], a[64:67], v[80:83], v[216:219]
    v_mov_b32 v247, v246
    s_nop 1
    v_permlane32_swap_b32 v246, v247
    v_mfma_f32_16x16x32_bf16 v[220:223], a[96:99], v[80:83], v[220:223]
    v_max_f32 v246, v246, v247
    v_mov_b32 v247, v246
    v_mfma_f32_16x16x32_bf16 v[224:227], a[128:131], v[80:83], v[224:227]
    s_nop 0
    v_permlane16_swap_b32 v246, v247
    v_max_f32 v246, v246, v247
    v_mfma_f32_16x16x32_bf16 v[216:219], a[68:71], v[92:95], v[216:219]
    v_mul_f32 v246, s53, v246
    v_fma_f32 v192, v192, s53, -v246
    v_mfma_f32_16x16x32_bf16 v[220:223], a[100:103], v[92:95], v[220:223]
    v_fma_f32 v193, v193, s53, -v246
    v_fma_f32 v194, v194, s53, -v246
    v_mfma_f32_16x16x32_bf16 v[224:227], a[132:135], v[92:95], v[224:227]
    v_fma_f32 v195, v195, s53, -v246
    v_fma_f32 v196, v196, s53, -v246
    v_fma_f32 v197, v197, s53, -v246
    v_cvt_pk_bf16_f32 v248, v204, v205
    v_cvt_pk_bf16_f32 v250, v216, v217
    v_fma_f32 v198, v198, s53, -v246
    v_lshlrev_b32 v204, 16, v248
    v_lshlrev_b32 v216, 16, v250
    v_fma_f32 v199, v199, s53, -v246
    v_and_b32 v205, 0xffff0000, v248
    v_and_b32 v217, 0xffff0000, v250
    v_fma_f32 v200, v200, s53, -v246
    v_cvt_pk_bf16_f32 v249, v206, v207
    v_cvt_pk_bf16_f32 v251, v218, v219
    v_fma_f32 v201, v201, s53, -v246
    v_lshlrev_b32 v206, 16, v249
    v_lshlrev_b32 v218, 16, v251
    v_fma_f32 v202, v202, s53, -v246
    v_and_b32 v207, 0xffff0000, v249
    v_and_b32 v219, 0xffff0000, v251
    v_fma_f32 v203, v203, s53, -v246
    v_cvt_pk_bf16_f32 v248, v208, v209
    v_cvt_pk_bf16_f32 v250, v220, v221
    v_exp_f32 v192, v192
    v_lshlrev_b32 v208, 16, v248
    v_lshlrev_b32 v220, 16, v250
    v_exp_f32 v193, v193
    v_and_b32 v209, 0xffff0000, v248
    v_and_b32 v221, 0xffff0000, v250
    v_exp_f32 v194, v194
    v_cvt_pk_bf16_f32 v249, v210, v211
    v_cvt_pk_bf16_f32 v251, v222, v223
    v_exp_f32 v195, v195
    v_lshlrev_b32 v210, 16, v249
    v_lshlrev_b32 v222, 16, v251
    v_exp_f32 v196, v196
    v_and_b32 v211, 0xffff0000, v249
    v_and_b32 v223, 0xffff0000, v251
    v_exp_f32 v197, v197
    v_cvt_pk_bf16_f32 v248, v212, v213
    v_cvt_pk_bf16_f32 v250, v224, v225
    v_exp_f32 v198, v198
    v_lshlrev_b32 v212, 16, v248
    v_lshlrev_b32 v224, 16, v250
    v_exp_f32 v199, v199
    v_and_b32 v213, 0xffff0000, v248
    v_and_b32 v225, 0xffff0000, v250
    v_exp_f32 v200, v200
    v_cvt_pk_bf16_f32 v249, v214, v215
    v_cvt_pk_bf16_f32 v251, v226, v227
    v_exp_f32 v201, v201
    v_lshlrev_b32 v214, 16, v249
    v_lshlrev_b32 v226, 16, v251
    v_exp_f32 v202, v202
    v_and_b32 v215, 0xffff0000, v249
    v_and_b32 v227, 0xffff0000, v251
    v_exp_f32 v203, v203
    v_max3_f32 v248, v204, v205, v206
    v_max3_f32 v250, v216, v217, v218
    v_add_f32 v246, v192, v193
    v_max3_f32 v249, v207, v208, v209
    v_max3_f32 v251, v219, v220, v221
    v_add_f32 v247, v194, v195
    v_max3_f32 v248, v248, v210, v211
    v_max3_f32 v250, v250, v222, v223
    v_add_f32 v246, v246, v196
    v_max3_f32 v249, v249, v212, v213
    v_max3_f32 v251, v251, v224, v225
    v_add_f32 v247, v247, v197
    v_max3_f32 v248, v248, v214, v215
    v_max3_f32 v250, v250, v226, v227
    v_add_f32 v246, v246, v198
    v_max_f32 v248, v248, v249
    v_max_f32 v250, v250, v251
    v_add_f32 v247, v247, v199
    v_mov_b32 v249, v248
    v_mov_b32 v251, v250
    v_add_f32 v246, v246, v200
    v_permlane32_swap_b32 v248, v249
    v_permlane32_swap_b32 v250, v251
    v_add_f32 v247, v247, v201
    v_max_f32 v248, v248, v249
    v_max_f32 v250, v250, v251
    v_add_f32 v246, v246, v202
    v_mov_b32 v249, v248
    v_mov_b32 v251, v250
    v_add_f32 v247, v247, v203
    v_permlane16_swap_b32 v248, v249
    v_permlane16_swap_b32 v250, v251
    v_add_f32 v246, v246, v247
    v_max_f32 v248, v248, v249
    v_max_f32 v250, v250, v251
    v_mov_b32 v247, v246
    v_mul_f32 v248, s53, v248
    v_mul_f32 v250, s53, v250
    v_permlane32_swap_b32 v246, v247
    v_fma_f32 v204, v204, s53, -v248
    v_fma_f32 v216, v216, s53, -v250
    v_add_f32 v246, v246, v247
    v_fma_f32 v205, v205, s53, -v248
    v_fma_f32 v217, v217, s53, -v250
    v_mov_b32 v247, v246
    v_fma_f32 v206, v206, s53, -v248
    v_fma_f32 v218, v218, s53, -v250
    v_permlane16_swap_b32 v246, v247
    v_fma_f32 v207, v207, s53, -v248
    v_fma_f32 v219, v219, s53, -v250
    v_add_f32 v246, v246, v247
    v_fma_f32 v208, v208, s53, -v248
    v_fma_f32 v220, v220, s53, -v250
    v_rcp_f32 v246, v246
    v_fma_f32 v209, v209, s53, -v248
    v_fma_f32 v221, v221, s53, -v250
    v_mul_f32 v192, v192, v246
    v_fma_f32 v210, v210, s53, -v248
    v_fma_f32 v222, v222, s53, -v250
    v_mul_f32 v193, v193, v246
    v_fma_f32 v211, v211, s53, -v248
    v_fma_f32 v223, v223, s53, -v250
    v_mul_f32 v194, v194, v246
    v_fma_f32 v212, v212, s53, -v248
    v_fma_f32 v224, v224, s53, -v250
    v_mul_f32 v195, v195, v246
    v_fma_f32 v213, v213, s53, -v248
    v_fma_f32 v225, v225, s53, -v250
    v_mul_f32 v196, v196, v246
    v_fma_f32 v214, v214, s53, -v248
    v_fma_f32 v226, v226, s53, -v250
    v_mul_f32 v197, v197, v246
    v_fma_f32 v215, v215, s53, -v248
    v_fma_f32 v227, v227, s53, -v250
    v_mul_f32 v198, v198, v246
    v_exp_f32 v204, v204
    v_exp_f32 v216, v216
    v_mul_f32 v199, v199, v246
    v_exp_f32 v205, v205
    v_exp_f32 v217, v217
    v_mul_f32 v200, v200, v246
    v_exp_f32 v206, v206
    v_exp_f32 v218, v218
    v_mul_f32 v201, v201, v246
    v_exp_f32 v207, v207
    v_exp_f32 v219, v219
    v_mul_f32 v202, v202, v246
    v_exp_f32 v208, v208
    v_exp_f32 v220, v220
    v_mul_f32 v203, v203, v246
    v_exp_f32 v209, v209
    v_exp_f32 v221, v221
    v_cvt_pk_bf16_f32 v96, v192, v193
    v_exp_f32 v210, v210
    v_exp_f32 v222, v222
    v_cvt_pk_bf16_f32 v97, v194, v195
    v_exp_f32 v211, v211
    v_exp_f32 v223, v223
    v_cvt_pk_bf16_f32 v98, v196, v197
    v_exp_f32 v212, v212
    v_exp_f32 v224, v224
    v_cvt_pk_bf16_f32 v99, v198, v199
    v_exp_f32 v213, v213
    v_exp_f32 v225, v225
    v_cvt_pk_bf16_f32 v100, v200, v201
    v_exp_f32 v214, v214
    v_exp_f32 v226, v226
    v_cvt_pk_bf16_f32 v101, v202, v203
    v_exp_f32 v215, v215
    v_exp_f32 v227, v227
    v_add_f32 v248, v204, v205
    v_add_f32 v250, v216, v217
    v_add_f32 v249, v206, v207
    v_add_f32 v251, v218, v219
    v_add_f32 v248, v248, v208
    v_add_f32 v250, v250, v220
    v_add_f32 v249, v249, v209
    v_add_f32 v251, v251, v221
    v_add_f32 v248, v248, v210
    v_add_f32 v250, v250, v222
    v_add_f32 v249, v249, v211
    v_add_f32 v251, v251, v223
    v_add_f32 v248, v248, v212
    v_add_f32 v250, v250, v224
    v_add_f32 v249, v249, v213
    v_add_f32 v251, v251, v225
    v_add_f32 v248, v248, v214
    v_add_f32 v250, v250, v226
    v_add_f32 v249, v249, v215
    v_add_f32 v251, v251, v227
    v_add_f32 v248, v248, v249
    v_add_f32 v250, v250, v251
    v_mov_b32 v249, v248
    v_mov_b32 v251, v250
    s_nop 0
    v_permlane32_swap_b32 v248, v249
    v_permlane32_swap_b32 v250, v251
    v_add_f32 v248, v248, v249
    v_add_f32 v250, v250, v251
    v_mov_b32 v249, v248
    v_mov_b32 v251, v250
    s_nop 0
    v_permlane16_swap_b32 v248, v249
    v_permlane16_swap_b32 v250, v251
    v_add_f32 v248, v248, v249
    v_add_f32 v250, v250, v251
    v_rcp_f32 v248, v248
    v_rcp_f32 v250, v250
    v_mul_f32 v204, v204, v248
    v_mul_f32 v216, v216, v250
    v_mul_f32 v205, v205, v248
    v_mul_f32 v217, v217, v250
    v_mul_f32 v206, v206, v248
    v_mul_f32 v218, v218, v250
    v_mul_f32 v207, v207, v248
    v_mul_f32 v219, v219, v250
    v_mul_f32 v208, v208, v248
    v_mul_f32 v220, v220, v250
    v_mul_f32 v209, v209, v248
    v_mul_f32 v221, v221, v250
    v_mul_f32 v210, v210, v248
    v_mul_f32 v222, v222, v250
    v_mul_f32 v211, v211, v248
    v_mul_f32 v223, v223, v250
    v_mul_f32 v212, v212, v248
    v_mul_f32 v224, v224, v250
    v_mul_f32 v213, v213, v248
    v_mul_f32 v225, v225, v250
    v_mul_f32 v214, v214, v248
    v_mul_f32 v226, v226, v250
    v_mul_f32 v215, v215, v248
    v_mul_f32 v227, v227, v250
    v_cvt_pk_bf16_f32 v102, v204, v205
    v_cvt_pk_bf16_f32 v108, v216, v217
    v_cvt_pk_bf16_f32 v103, v206, v207
    v_cvt_pk_bf16_f32 v109, v218, v219
    v_cvt_pk_bf16_f32 v104, v208, v209
    v_cvt_pk_bf16_f32 v110, v220, v221
    v_cvt_pk_bf16_f32 v105, v210, v211
    v_cvt_pk_bf16_f32 v111, v222, v223
    v_cvt_pk_bf16_f32 v106, v212, v213
    v_cvt_pk_bf16_f32 v112, v224, v225
    v_cvt_pk_bf16_f32 v107, v214, v215
    v_cvt_pk_bf16_f32 v113, v226, v227
    v_add_u32 v162, s3, v242
    v_add_u32 v163, s61, v243
    ds_write_b128 v162, v[96:99] offset:0
    ds_write_b128 v162, v[102:105] offset:1024
    ds_write_b128 v162, v[108:111] offset:2048
    s_mov_b64 exec, s[100:101]
    ds_write_b64 v243, v[100:101] offset:0
    ds_write_b64 v243, v[106:107] offset:512
    ds_write_b64 v243, v[112:113] offset:1024
    s_mov_b64 exec, -1
    s_waitcnt vmcnt(0) lgkmcnt(0)
    s_barrier
    ds_read_b128 v[0:3], v233 offset:0
    ds_read_b128 v[32:35], v233 offset:8192
    ds_read_b128 v[64:67], v233 offset:16384
    ds_read_b128 v[4:7], v234 offset:0
    ds_read_b128 v[36:39], v234 offset:8192
    ds_read_b128 v[68:71], v234 offset:16384
    ds_read_b128 v[8:11], v235 offset:0
    ds_read_b128 v[40:43], v235 offset:8192
    ds_read_b128 v[72:75], v235 offset:16384
    ds_read_b64_tr_b16 a[0:1], v239 offset:0
    ds_read_b64_tr_b16 a[2:3], v239 offset:2048
    ds_read_b64_tr_b16 a[4:5], v240 offset:0
    ds_read_b64_tr_b16 a[6:7], v240 offset:2048
    ds_read_b64_tr_b16 a[8:9], v239 offset:4096
    ds_read_b64_tr_b16 a[10:11], v239 offset:6144
    ds_read_b64_tr_b16 a[12:13], v240 offset:4096
    ds_read_b64_tr_b16 a[14:15], v240 offset:6144
    ds_read_b64_tr_b16 a[16:17], v239 offset:8192
    ds_read_b64_tr_b16 a[18:19], v239 offset:10240
    ds_read_b64_tr_b16 a[20:21], v240 offset:8192
    ds_read_b64_tr_b16 a[22:23], v240 offset:10240
    ds_read_b64_tr_b16 a[24:25], v239 offset:12288
    ds_read_b64_tr_b16 a[26:27], v239 offset:14336
    s_waitcnt lgkmcnt(10)
    v_mfma_f32_16x16x32_bf16 v[180:183], v[0:3], a[0:3], 0
    ds_read_b64_tr_b16 a[28:29], v240 offset:12288
    v_mfma_f32_16x16x32_bf16 v[184:187], v[32:35], a[0:3], 0
    ds_read_b64_tr_b16 a[30:31], v240 offset:14336
    v_mfma_f32_16x16x32_bf16 v[188:191], v[64:67], a[0:3], 0
    ds_read_b128 v[12:15], v236 offset:0
    v_mfma_f32_16x16x32_bf16 v[192:195], v[0:3], a[4:7], 0
    ds_read_b64_tr_b16 a[0:1], v239 offset:16384
    v_mfma_f32_16x16x32_bf16 v[196:199], v[32:35], a[4:7], 0
    ds_read_b64_tr_b16 a[2:3], v239 offset:18432
    v_mfma_f32_16x16x32_bf16 v[200:203], v[64:67], a[4:7], 0
    ds_read_b128 v[44:47], v236 offset:8192
    s_waitcnt lgkmcnt(12)
    v_mfma_f32_16x16x32_bf16 v[180:183], v[4:7], a[8:11], v[180:183]
    ds_read_b64_tr_b16 a[4:5], v240 offset:16384
    v_mfma_f32_16x16x32_bf16 v[184:187], v[36:39], a[8:11], v[184:187]
    ds_read_b64_tr_b16 a[6:7], v240 offset:18432
    v_mfma_f32_16x16x32_bf16 v[188:191], v[68:71], a[8:11], v[188:191]
    ds_read_b128 v[76:79], v236 offset:16384
    v_mfma_f32_16x16x32_bf16 v[192:195], v[4:7], a[12:15], v[192:195]
    ds_read_b64_tr_b16 a[8:9], v239 offset:20480
    v_mfma_f32_16x16x32_bf16 v[196:199], v[36:39], a[12:15], v[196:199]
    ds_read_b64_tr_b16 a[10:11], v239 offset:22528
    v_mfma_f32_16x16x32_bf16 v[200:203], v[68:71], a[12:15], v[200:203]
    ds_read_b128 v[16:19], v233 offset:4096
    s_waitcnt lgkmcnt(14)
    v_mfma_f32_16x16x32_bf16 v[180:183], v[8:11], a[16:19], v[180:183]
    ds_read_b64_tr_b16 a[12:13], v240 offset:20480
    v_mfma_f32_16x16x32_bf16 v[184:187], v[40:43], a[16:19], v[184:187]
    ds_read_b64_tr_b16 a[14:15], v240 offset:22528
    v_mfma_f32_16x16x32_bf16 v[188:191], v[72:75], a[16:19], v[188:191]
    ds_read_b128 v[48:51], v233 offset:12288
    v_mfma_f32_16x16x32_bf16 v[192:195], v[8:11], a[20:23], v[192:195]
    ds_read_b64_tr_b16 a[16:17], v239 offset:24576
    v_mfma_f32_16x16x32_bf16 v[196:199], v[40:43], a[20:23], v[196:199]
    ds_read_b64_tr_b16 a[18:19], v239 offset:26624
    v_mfma_f32_16x16x32_bf16 v[200:203], v[72:75], a[20:23], v[200:203]
    ds_read_b128 v[80:83], v233 offset:20480
    s_waitcnt lgkmcnt(15)
    v_mfma_f32_16x16x32_bf16 v[180:183], v[12:15], a[24:27], v[180:183]
    ds_read_b64_tr_b16 a[20:21], v240 offset:24576
    s_waitcnt lgkmcnt(13)
    v_mfma_f32_16x16x32_bf16 v[184:187], v[44:47], a[24:27], v[184:187]
    ds_read_b64_tr_b16 a[22:23], v240 offset:26624
    s_waitcnt lgkmcnt(11)
    v_mfma_f32_16x16x32_bf16 v[188:191], v[76:79], a[24:27], v[188:191]
    ds_read_b128 v[20:23], v234 offset:4096
    v_mfma_f32_16x16x32_bf16 v[192:195], v[12:15], a[28:31], v[192:195]
    ds_read_b64_tr_b16 a[24:25], v239 offset:28672
    v_mfma_f32_16x16x32_bf16 v[196:199], v[44:47], a[28:31], v[196:199]
    ds_read_b64_tr_b16 a[26:27], v239 offset:30720
    v_mfma_f32_16x16x32_bf16 v[200:203], v[76:79], a[28:31], v[200:203]
    ds_read_b128 v[52:55], v234 offset:12288
    s_waitcnt lgkmcnt(12)
    v_mfma_f32_16x16x32_bf16 v[180:183], v[16:19], a[0:3], v[180:183]
    ds_read_b64_tr_b16 a[28:29], v240 offset:28672
    s_waitcnt lgkmcnt(10)
    v_mfma_f32_16x16x32_bf16 v[184:187], v[48:51], a[0:3], v[184:187]
    ds_read_b64_tr_b16 a[30:31], v240 offset:30720
    s_waitcnt lgkmcnt(8)
    v_mfma_f32_16x16x32_bf16 v[188:191], v[80:83], a[0:3], v[188:191]
    ds_read_b128 v[84:87], v234 offset:20480
    v_mfma_f32_16x16x32_bf16 v[192:195], v[16:19], a[4:7], v[192:195]
    ds_read_b128 v[24:27], v235 offset:4096
    v_mfma_f32_16x16x32_bf16 v[196:199], v[48:51], a[4:7], v[196:199]
    ds_read_b128 v[56:59], v235 offset:12288
    v_mfma_f32_16x16x32_bf16 v[200:203], v[80:83], a[4:7], v[200:203]
    ds_read_b128 v[88:91], v235 offset:20480
    s_waitcnt lgkmcnt(9)
    v_mfma_f32_16x16x32_bf16 v[180:183], v[20:23], a[8:11], v[180:183]
    ds_read_b128 v[28:31], v236 offset:4096
    s_waitcnt lgkmcnt(7)
    v_mfma_f32_16x16x32_bf16 v[184:187], v[52:55], a[8:11], v[184:187]
    ds_read_b128 v[60:63], v236 offset:12288
    s_waitcnt lgkmcnt(5)
    v_mfma_f32_16x16x32_bf16 v[188:191], v[84:87], a[8:11], v[188:191]
    ds_read_b128 v[92:95], v236 offset:20480
    s_waitcnt lgkmcnt(0)
    s_barrier
    v_mfma_f32_16x16x32_bf16 v[192:195], v[20:23], a[12:15], v[192:195]
    ds_read_b64_tr_b16 a[0:1], v237 offset:0
    s_add_u32 s47, s59, 384
    v_mfma_f32_16x16x32_bf16 v[196:199], v[52:55], a[12:15], v[196:199]
    ds_read_b64_tr_b16 a[2:3], v237 offset:2048
    s_add_u32 s48, s59, 29056
    v_mfma_f32_16x16x32_bf16 v[200:203], v[84:87], a[12:15], v[200:203]
    ds_read_b64_tr_b16 a[4:5], v238 offset:0
    v_mfma_f32_16x16x32_bf16 v[180:183], v[24:27], a[16:19], v[180:183]
    ds_read_b64_tr_b16 a[6:7], v238 offset:2048
    s_add_u32 m0, s50, 65536
    v_mfma_f32_16x16x32_bf16 v[184:187], v[56:59], a[16:19], v[184:187]
    buffer_load_dwordx4 v228, s[24:27], s47 offen offset:0 lds
    v_mfma_f32_16x16x32_bf16 v[188:191], v[88:91], a[16:19], v[188:191]
    ds_read_b64_tr_b16 a[8:9], v237 offset:4096
    s_add_u32 s49, s58, 24576
    v_mfma_f32_16x16x32_bf16 v[192:195], v[24:27], a[20:23], v[192:195]
    ds_read_b64_tr_b16 a[10:11], v237 offset:6144
    v_mfma_f32_16x16x32_bf16 v[196:199], v[56:59], a[20:23], v[196:199]
    buffer_load_dwordx4 v229, s[24:27], s47 offen offset:1024 lds
    v_mfma_f32_16x16x32_bf16 v[200:203], v[88:91], a[20:23], v[200:203]
    ds_read_b64_tr_b16 a[12:13], v238 offset:4096
    v_mfma_f32_16x16x32_bf16 v[180:183], v[28:31], a[24:27], v[180:183]
    ds_read_b64_tr_b16 a[14:15], v238 offset:6144
    v_mfma_f32_16x16x32_bf16 v[184:187], v[60:63], a[24:27], v[184:187]
    buffer_load_dwordx4 v230, s[24:27], s47 offen offset:2048 lds
    v_mfma_f32_16x16x32_bf16 v[188:191], v[92:95], a[24:27], v[188:191]
    ds_read_b64_tr_b16 a[16:17], v237 offset:8192
    v_mfma_f32_16x16x32_bf16 v[192:195], v[28:31], a[28:31], v[192:195]
    ds_read_b64_tr_b16 a[18:19], v237 offset:10240
    v_mfma_f32_16x16x32_bf16 v[196:199], v[60:63], a[28:31], v[196:199]
    buffer_load_dwordx4 v231, s[24:27], s47 offen offset:3072 lds
    v_mfma_f32_16x16x32_bf16 v[200:203], v[92:95], a[28:31], v[200:203]
    ds_read_b64_tr_b16 a[20:21], v238 offset:8192
    s_waitcnt lgkmcnt(7)
    v_mfma_f32_16x16x32_bf16 v[204:207], v[0:3], a[0:3], 0
    ds_read_b64_tr_b16 a[22:23], v238 offset:10240
    s_add_u32 m0, s50, 69632
    v_mfma_f32_16x16x32_bf16 v[208:211], v[32:35], a[0:3], 0
    buffer_load_dwordx4 v228, s[24:27], s48 offen offset:0 lds
    v_mfma_f32_16x16x32_bf16 v[212:215], v[64:67], a[0:3], 0
    ds_read_b64_tr_b16 a[24:25], v237 offset:12288
    v_mfma_f32_16x16x32_bf16 v[216:219], v[0:3], a[4:7], 0
    ds_read_b64_tr_b16 a[26:27], v237 offset:14336
    v_mfma_f32_16x16x32_bf16 v[220:223], v[32:35], a[4:7], 0
    buffer_load_dwordx4 v229, s[24:27], s48 offen offset:1024 lds
    v_mfma_f32_16x16x32_bf16 v[224:227], v[64:67], a[4:7], 0
    ds_read_b64_tr_b16 a[28:29], v238 offset:12288
    s_waitcnt lgkmcnt(7)
    v_mfma_f32_16x16x32_bf16 v[204:207], v[4:7], a[8:11], v[204:207]
    ds_read_b64_tr_b16 a[30:31], v238 offset:14336
    v_cvt_pk_bf16_f32 v150, v180, v181
    v_mfma_f32_16x16x32_bf16 v[208:211], v[36:39], a[8:11], v[208:211]
    buffer_load_dwordx4 v230, s[24:27], s48 offen offset:2048 lds
    v_mfma_f32_16x16x32_bf16 v[212:215], v[68:71], a[8:11], v[212:215]
    ds_read_b64_tr_b16 a[0:1], v237 offset:16384
    v_cvt_pk_bf16_f32 v151, v182, v183
    v_mfma_f32_16x16x32_bf16 v[216:219], v[4:7], a[12:15], v[216:219]
    ds_read_b64_tr_b16 a[2:3], v237 offset:18432
    v_cvt_pk_bf16_f32 v152, v184, v185
    v_mfma_f32_16x16x32_bf16 v[220:223], v[36:39], a[12:15], v[220:223]
    buffer_load_dwordx4 v231, s[24:27], s48 offen offset:3072 lds
    v_mfma_f32_16x16x32_bf16 v[224:227], v[68:71], a[12:15], v[224:227]
    ds_read_b64_tr_b16 a[4:5], v238 offset:16384
    s_waitcnt lgkmcnt(7)
    v_mfma_f32_16x16x32_bf16 v[204:207], v[8:11], a[16:19], v[204:207]
    ds_read_b64_tr_b16 a[6:7], v238 offset:18432
    v_cvt_pk_bf16_f32 v153, v186, v187
    v_mfma_f32_16x16x32_bf16 v[208:211], v[40:43], a[16:19], v[208:211]
    ds_read_b64_tr_b16 a[8:9], v237 offset:20480
    v_cvt_pk_bf16_f32 v158, v188, v189
    v_mfma_f32_16x16x32_bf16 v[212:215], v[72:75], a[16:19], v[212:215]
    ds_read_b64_tr_b16 a[10:11], v237 offset:22528
    v_cvt_pk_bf16_f32 v159, v190, v191
    v_mfma_f32_16x16x32_bf16 v[216:219], v[8:11], a[20:23], v[216:219]
    ds_read_b64_tr_b16 a[12:13], v238 offset:20480
    v_cvt_pk_bf16_f32 v154, v192, v193
    v_mfma_f32_16x16x32_bf16 v[220:223], v[40:43], a[20:23], v[220:223]
    ds_read_b64_tr_b16 a[14:15], v238 offset:22528
    v_cvt_pk_bf16_f32 v155, v194, v195
    v_mfma_f32_16x16x32_bf16 v[224:227], v[72:75], a[20:23], v[224:227]
    ds_read_b64_tr_b16 a[16:17], v237 offset:24576
    s_waitcnt lgkmcnt(9)
    v_mfma_f32_16x16x32_bf16 v[204:207], v[12:15], a[24:27], v[204:207]
    ds_read_b64_tr_b16 a[18:19], v237 offset:26624
    v_cvt_pk_bf16_f32 v156, v196, v197
    v_mfma_f32_16x16x32_bf16 v[208:211], v[44:47], a[24:27], v[208:211]
    ds_read_b64_tr_b16 a[20:21], v238 offset:24576
    v_cvt_pk_bf16_f32 v157, v198, v199
    v_mfma_f32_16x16x32_bf16 v[212:215], v[76:79], a[24:27], v[212:215]
    ds_read_b64_tr_b16 a[22:23], v238 offset:26624
    v_cvt_pk_bf16_f32 v160, v200, v201
    v_cvt_pk_bf16_f32 v161, v202, v203
    v_accvgpr_write_b32 a32, v158
    v_accvgpr_write_b32 a33, v159
    v_accvgpr_write_b32 a36, v160
    v_accvgpr_write_b32 a37, v161
    ds_read_b128 v[114:117], v242 offset:0
    s_waitcnt lgkmcnt(0)
    v_mfma_f32_16x16x32_bf16 a[40:43], v[150:153], v[114:117], 0
    ds_read_b128 v[118:121], v242 offset:1024
    s_add_u32 m0, s51, 0
    s_waitcnt lgkmcnt(0)
    v_mfma_f32_16x16x32_bf16 a[44:47], v[150:153], v[118:121], 0
    buffer_load_dwordx4 v232, s[16:19], s49 offen nt lds
    ds_read_b128 v[122:125], v242 offset:2048
    s_waitcnt lgkmcnt(0)
    v_mfma_f32_16x16x32_bf16 a[48:51], v[150:153], v[122:125], 0
    ds_read_b64 v[138:139], v243 offset:0
    s_add_u32 s49, s58, 32768
    v_mfma_f32_16x16x32_bf16 a[52:55], v[154:157], v[114:117], 0
    ds_read_b64 v[142:143], v243 offset:512
    s_add_u32 m0, s51, 8192
    v_mfma_f32_16x16x32_bf16 a[56:59], v[154:157], v[118:121], 0
    buffer_load_dwordx4 v232, s[16:19], s49 offen nt lds
    v_mfma_f32_16x16x32_bf16 a[60:63], v[154:157], v[122:125], 0
    ds_read_b64 v[146:147], v243 offset:1024
    s_add_u32 s49, s58, 40960
    v_mfma_f32_16x16x32_bf16 v[216:219], v[12:15], a[28:31], v[216:219]
    ds_read_b64_tr_b16 a[24:25], v237 offset:28672
    s_add_u32 m0, s51, 16384
    v_mfma_f32_16x16x32_bf16 v[220:223], v[44:47], a[28:31], v[220:223]
    buffer_load_dwordx4 v232, s[16:19], s49 offen nt lds
    v_mfma_f32_16x16x32_bf16 v[224:227], v[76:79], a[28:31], v[224:227]
    ds_read_b64_tr_b16 a[26:27], v237 offset:30720
    v_mfma_f32_16x16x32_bf16 v[204:207], v[16:19], a[0:3], v[204:207]
    ds_read_b64_tr_b16 a[28:29], v238 offset:28672
    s_add_u32 s49, s58, 417792
    v_mfma_f32_16x16x32_bf16 v[208:211], v[48:51], a[0:3], v[208:211]
    ds_read_b64_tr_b16 a[30:31], v238 offset:30720
    s_add_u32 m0, s51, 24576
    v_mfma_f32_16x16x32_bf16 v[212:215], v[80:83], a[0:3], v[212:215]
    buffer_load_dwordx4 v232, s[16:19], s49 offen nt lds
    v_mfma_f32_16x16x32_bf16 v[216:219], v[16:19], a[4:7], v[216:219]
    s_add_u32 s49, s58, 425984
    s_add_u32 m0, s51, 32768
    v_mfma_f32_16x16x32_bf16 v[220:223], v[48:51], a[4:7], v[220:223]
    buffer_load_dwordx4 v232, s[16:19], s49 offen nt lds
    v_mfma_f32_16x16x32_bf16 v[224:227], v[80:83], a[4:7], v[224:227]
    s_add_u32 s49, s58, 434176
    v_mfma_f32_16x16x32_bf16 v[204:207], v[20:23], a[8:11], v[204:207]
    s_add_u32 m0, s51, 40960
    v_mfma_f32_16x16x32_bf16 v[208:211], v[52:55], a[8:11], v[208:211]
    buffer_load_dwordx4 v232, s[16:19], s49 offen nt lds
    v_mfma_f32_16x16x32_bf16 v[212:215], v[84:87], a[8:11], v[212:215]
    s_waitcnt lgkmcnt(0)
    s_barrier
    v_mfma_f32_16x16x32_bf16 v[216:219], v[20:23], a[12:15], v[216:219]
    ds_read_b64_tr_b16 a[0:1], v237 offset:32768
    s_add_u32 s47, s59, 512
    v_mfma_f32_16x16x32_bf16 v[220:223], v[52:55], a[12:15], v[220:223]
    ds_read_b64_tr_b16 a[2:3], v237 offset:34816
    s_add_u32 s48, s59, 29184
    v_mfma_f32_16x16x32_bf16 v[224:227], v[84:87], a[12:15], v[224:227]
    ds_read_b64_tr_b16 a[4:5], v238 offset:32768
    v_mfma_f32_16x16x32_bf16 v[204:207], v[24:27], a[16:19], v[204:207]
    ds_read_b64_tr_b16 a[6:7], v238 offset:34816
    s_add_u32 m0, s50, 0
    v_mfma_f32_16x16x32_bf16 v[208:211], v[56:59], a[16:19], v[208:211]
    buffer_load_dwordx4 v228, s[24:27], s47 offen offset:0 lds
    v_mfma_f32_16x16x32_bf16 v[212:215], v[88:91], a[16:19], v[212:215]
    ds_read_b64_tr_b16 a[8:9], v237 offset:36864
    s_add_u32 s55, s91, 229376
    v_mfma_f32_16x16x32_bf16 v[216:219], v[24:27], a[20:23], v[216:219]
    ds_read_b64_tr_b16 a[10:11], v237 offset:38912
    v_mfma_f32_16x16x32_bf16 v[220:223], v[56:59], a[20:23], v[220:223]
    ds_read_b64_tr_b16 a[12:13], v238 offset:36864
    v_mfma_f32_16x16x32_bf16 v[224:227], v[88:91], a[20:23], v[224:227]
    ds_read_b64_tr_b16 a[14:15], v238 offset:38912
    v_mfma_f32_16x16x32_bf16 v[204:207], v[28:31], a[24:27], v[204:207]
    buffer_load_dwordx4 v229, s[24:27], s47 offen offset:1024 lds
    v_mfma_f32_16x16x32_bf16 v[208:211], v[60:63], a[24:27], v[208:211]
    ds_read_b64_tr_b16 a[16:17], v237 offset:40960
    v_mfma_f32_16x16x32_bf16 v[212:215], v[92:95], a[24:27], v[212:215]
    ds_read_b64_tr_b16 a[18:19], v237 offset:43008
    v_mfma_f32_16x16x32_bf16 v[216:219], v[28:31], a[28:31], v[216:219]
    ds_read_b64_tr_b16 a[20:21], v238 offset:40960
    v_mfma_f32_16x16x32_bf16 v[220:223], v[60:63], a[28:31], v[220:223]
    ds_read_b64_tr_b16 a[22:23], v238 offset:43008
    v_mfma_f32_16x16x32_bf16 v[224:227], v[92:95], a[28:31], v[224:227]
    ds_read_b64_tr_b16 a[24:25], v237 offset:45056
    s_waitcnt lgkmcnt(9)
    v_mfma_f32_16x16x32_bf16 v[180:183], v[0:3], a[0:3], 0
    buffer_load_dwordx4 v230, s[24:27], s47 offen offset:2048 lds
    v_mfma_f32_16x16x32_bf16 v[184:187], v[32:35], a[0:3], 0
    ds_read_b64_tr_b16 a[26:27], v237 offset:47104
    v_mfma_f32_16x16x32_bf16 v[188:191], v[64:67], a[0:3], 0
    ds_read_b64_tr_b16 a[28:29], v238 offset:45056
    v_mfma_f32_16x16x32_bf16 v[192:195], v[0:3], a[4:7], 0
    ds_read_b64_tr_b16 a[30:31], v238 offset:47104
    v_mfma_f32_16x16x32_bf16 v[196:199], v[32:35], a[4:7], 0
    ds_read_b64_tr_b16 a[0:1], v237 offset:49152
    v_mfma_f32_16x16x32_bf16 v[200:203], v[64:67], a[4:7], 0
    ds_read_b64_tr_b16 a[2:3], v237 offset:51200
    s_waitcnt lgkmcnt(10)
    v_mfma_f32_16x16x32_bf16 v[180:183], v[4:7], a[8:11], v[180:183]
    buffer_load_dwordx4 v231, s[24:27], s47 offen offset:3072 lds
    v_mfma_f32_16x16x32_bf16 v[184:187], v[36:39], a[8:11], v[184:187]
    ds_read_b64_tr_b16 a[4:5], v238 offset:49152
    v_cvt_pk_bf16_f32 v150, v204, v205
    v_mfma_f32_16x16x32_bf16 v[188:191], v[68:71], a[8:11], v[188:191]
    ds_read_b64_tr_b16 a[6:7], v238 offset:51200
    v_cvt_pk_bf16_f32 v151, v206, v207
    v_mfma_f32_16x16x32_bf16 v[192:195], v[4:7], a[12:15], v[192:195]
    ds_read_b64_tr_b16 a[8:9], v237 offset:53248
    v_cvt_pk_bf16_f32 v152, v208, v209
    v_mfma_f32_16x16x32_bf16 v[196:199], v[36:39], a[12:15], v[196:199]
    ds_read_b64_tr_b16 a[10:11], v237 offset:55296
    v_cvt_pk_bf16_f32 v153, v210, v211
    v_mfma_f32_16x16x32_bf16 v[200:203], v[68:71], a[12:15], v[200:203]
    v_cvt_pk_bf16_f32 v158, v212, v213
    s_waitcnt lgkmcnt(10)
    v_mfma_f32_16x16x32_bf16 v[180:183], v[8:11], a[16:19], v[180:183]
    ds_read_b64_tr_b16 a[12:13], v238 offset:53248
    v_cvt_pk_bf16_f32 v159, v214, v215
    v_mfma_f32_16x16x32_bf16 v[184:187], v[40:43], a[16:19], v[184:187]
    ds_read_b64_tr_b16 a[14:15], v238 offset:55296
    v_cvt_pk_bf16_f32 v154, v216, v217
    v_mfma_f32_16x16x32_bf16 v[188:191], v[72:75], a[16:19], v[188:191]
    v_cvt_pk_bf16_f32 v155, v218, v219
    v_cvt_pk_bf16_f32 v156, v220, v221
    v_mfma_f32_16x16x32_bf16 v[192:195], v[8:11], a[20:23], v[192:195]
    ds_read_b64_tr_b16 a[16:17], v237 offset:57344
    v_cvt_pk_bf16_f32 v157, v222, v223
    v_mfma_f32_16x16x32_bf16 v[196:199], v[40:43], a[20:23], v[196:199]
    ds_read_b64_tr_b16 a[18:19], v237 offset:59392
    v_cvt_pk_bf16_f32 v160, v224, v225
    v_mfma_f32_16x16x32_bf16 v[200:203], v[72:75], a[20:23], v[200:203]
    v_cvt_pk_bf16_f32 v161, v226, v227
    s_waitcnt lgkmcnt(10)
    v_mfma_f32_16x16x32_bf16 v[180:183], v[12:15], a[24:27], v[180:183]
    ds_read_b64_tr_b16 a[20:21], v238 offset:57344
    v_accvgpr_write_b32 a208, v158
    v_mfma_f32_16x16x32_bf16 v[184:187], v[44:47], a[24:27], v[184:187]
    ds_read_b64_tr_b16 a[22:23], v238 offset:59392
    v_accvgpr_write_b32 a209, v159
    v_mfma_f32_16x16x32_bf16 v[188:191], v[76:79], a[24:27], v[188:191]
    v_accvgpr_write_b32 a212, v160
    v_accvgpr_write_b32 a213, v161
    v_mfma_f32_16x16x32_bf16 a[64:67], v[150:153], v[114:117], 0
    s_add_u32 m0, s50, 4096
    v_mfma_f32_16x16x32_bf16 a[68:71], v[150:153], v[118:121], 0
    buffer_load_dwordx4 v228, s[24:27], s48 offen offset:0 lds
    v_mfma_f32_16x16x32_bf16 a[72:75], v[150:153], v[122:125], 0
    v_mfma_f32_16x16x32_bf16 a[76:79], v[154:157], v[114:117], 0
    v_mfma_f32_16x16x32_bf16 a[80:83], v[154:157], v[118:121], 0
    buffer_load_dwordx4 v229, s[24:27], s48 offen offset:1024 lds
    v_mfma_f32_16x16x32_bf16 a[84:87], v[154:157], v[122:125], 0
    v_mfma_f32_16x16x32_bf16 v[192:195], v[12:15], a[28:31], v[192:195]
    ds_read_b64_tr_b16 a[24:25], v237 offset:61440
    v_mfma_f32_16x16x32_bf16 v[196:199], v[44:47], a[28:31], v[196:199]
    buffer_load_dwordx4 v230, s[24:27], s48 offen offset:2048 lds
    v_mfma_f32_16x16x32_bf16 v[200:203], v[76:79], a[28:31], v[200:203]
    ds_read_b64_tr_b16 a[26:27], v237 offset:63488
    s_waitcnt lgkmcnt(10)
    v_mfma_f32_16x16x32_bf16 v[180:183], v[16:19], a[0:3], v[180:183]
    ds_read_b64_tr_b16 a[28:29], v238 offset:61440
    v_mfma_f32_16x16x32_bf16 v[184:187], v[48:51], a[0:3], v[184:187]
    buffer_load_dwordx4 v231, s[24:27], s48 offen offset:3072 lds
    v_mfma_f32_16x16x32_bf16 v[188:191], v[80:83], a[0:3], v[188:191]
    ds_read_b64_tr_b16 a[30:31], v238 offset:63488
    v_mfma_f32_16x16x32_bf16 v[192:195], v[16:19], a[4:7], v[192:195]
    v_mfma_f32_16x16x32_bf16 v[196:199], v[48:51], a[4:7], v[196:199]
    buffer_load_dword v245, v244, s[24:27], s55 offen
    v_mfma_f32_16x16x32_bf16 v[200:203], v[80:83], a[4:7], v[200:203]
    s_waitcnt lgkmcnt(8)
    v_mfma_f32_16x16x32_bf16 v[180:183], v[20:23], a[8:11], v[180:183]
    v_mfma_f32_16x16x32_bf16 v[184:187], v[52:55], a[8:11], v[184:187]
    v_mfma_f32_16x16x32_bf16 v[188:191], v[84:87], a[8:11], v[188:191]
    s_waitcnt vmcnt(15) lgkmcnt(0)
    s_barrier
    v_mfma_f32_16x16x32_bf16 v[192:195], v[20:23], a[12:15], v[192:195]
    ds_read_b64_tr_b16 a[0:1], v239 offset:0
    s_add_u32 s47, s59, 640
    v_mfma_f32_16x16x32_bf16 v[196:199], v[52:55], a[12:15], v[196:199]
    ds_read_b64_tr_b16 a[2:3], v239 offset:2048
    s_add_u32 s48, s59, 29312
    v_mfma_f32_16x16x32_bf16 v[200:203], v[84:87], a[12:15], v[200:203]
    ds_read_b64_tr_b16 a[4:5], v240 offset:0
    v_mfma_f32_16x16x32_bf16 v[180:183], v[24:27], a[16:19], v[180:183]
    ds_read_b64_tr_b16 a[6:7], v240 offset:2048
    s_add_u32 m0, s50, 32768
    v_mfma_f32_16x16x32_bf16 v[184:187], v[56:59], a[16:19], v[184:187]
    buffer_load_dwordx4 v228, s[24:27], s47 offen offset:0 lds
    v_mfma_f32_16x16x32_bf16 v[188:191], v[88:91], a[16:19], v[188:191]
    ds_read_b64_tr_b16 a[8:9], v239 offset:4096
    v_mfma_f32_16x16x32_bf16 v[192:195], v[24:27], a[20:23], v[192:195]
    ds_read_b64_tr_b16 a[10:11], v239 offset:6144
    v_mfma_f32_16x16x32_bf16 v[196:199], v[56:59], a[20:23], v[196:199]
    ds_read_b64_tr_b16 a[12:13], v240 offset:4096
    v_mfma_f32_16x16x32_bf16 v[200:203], v[88:91], a[20:23], v[200:203]
    ds_read_b64_tr_b16 a[14:15], v240 offset:6144
    v_mfma_f32_16x16x32_bf16 v[180:183], v[28:31], a[24:27], v[180:183]
    ds_read_b64_tr_b16 a[16:17], v239 offset:8192
    v_mfma_f32_16x16x32_bf16 v[184:187], v[60:63], a[24:27], v[184:187]
    buffer_load_dwordx4 v229, s[24:27], s47 offen offset:1024 lds
    v_mfma_f32_16x16x32_bf16 v[188:191], v[92:95], a[24:27], v[188:191]
    ds_read_b64_tr_b16 a[18:19], v239 offset:10240
    v_mfma_f32_16x16x32_bf16 v[192:195], v[28:31], a[28:31], v[192:195]
    ds_read_b64_tr_b16 a[20:21], v240 offset:8192
    v_mfma_f32_16x16x32_bf16 v[196:199], v[60:63], a[28:31], v[196:199]
    ds_read_b64_tr_b16 a[22:23], v240 offset:10240
    v_mfma_f32_16x16x32_bf16 v[200:203], v[92:95], a[28:31], v[200:203]
    ds_read_b64_tr_b16 a[24:25], v239 offset:12288
    s_waitcnt lgkmcnt(9)
    v_mfma_f32_16x16x32_bf16 v[204:207], v[0:3], a[0:3], 0
    ds_read_b64_tr_b16 a[26:27], v239 offset:14336
    v_mfma_f32_16x16x32_bf16 v[208:211], v[32:35], a[0:3], 0
    buffer_load_dwordx4 v230, s[24:27], s47 offen offset:2048 lds
    v_mfma_f32_16x16x32_bf16 v[212:215], v[64:67], a[0:3], 0
    ds_read_b64_tr_b16 a[28:29], v240 offset:12288
    v_mfma_f32_16x16x32_bf16 v[216:219], v[0:3], a[4:7], 0
    ds_read_b64_tr_b16 a[30:31], v240 offset:14336
    v_mfma_f32_16x16x32_bf16 v[220:223], v[32:35], a[4:7], 0
    ds_read_b64_tr_b16 a[0:1], v239 offset:16384
    v_mfma_f32_16x16x32_bf16 v[224:227], v[64:67], a[4:7], 0
    ds_read_b64_tr_b16 a[2:3], v239 offset:18432
    s_waitcnt lgkmcnt(10)
    v_mfma_f32_16x16x32_bf16 v[204:207], v[4:7], a[8:11], v[204:207]
    ds_read_b64_tr_b16 a[4:5], v240 offset:16384
    v_cvt_pk_bf16_f32 v150, v180, v181
    v_mfma_f32_16x16x32_bf16 v[208:211], v[36:39], a[8:11], v[208:211]
    buffer_load_dwordx4 v231, s[24:27], s47 offen offset:3072 lds
    v_mfma_f32_16x16x32_bf16 v[212:215], v[68:71], a[8:11], v[212:215]
    ds_read_b64_tr_b16 a[6:7], v240 offset:18432
    v_cvt_pk_bf16_f32 v151, v182, v183
    v_mfma_f32_16x16x32_bf16 v[216:219], v[4:7], a[12:15], v[216:219]
    ds_read_b64_tr_b16 a[8:9], v239 offset:20480
    v_cvt_pk_bf16_f32 v152, v184, v185
    v_mfma_f32_16x16x32_bf16 v[220:223], v[36:39], a[12:15], v[220:223]
    ds_read_b64_tr_b16 a[10:11], v239 offset:22528
    v_cvt_pk_bf16_f32 v153, v186, v187
    v_mfma_f32_16x16x32_bf16 v[224:227], v[68:71], a[12:15], v[224:227]
    ds_write_b64 v163, v[100:101] offset:0
    s_waitcnt lgkmcnt(11)
    v_mfma_f32_16x16x32_bf16 v[204:207], v[8:11], a[16:19], v[204:207]
    ds_read_b64_tr_b16 a[12:13], v240 offset:20480
    v_cvt_pk_bf16_f32 v158, v188, v189
    v_mfma_f32_16x16x32_bf16 v[208:211], v[40:43], a[16:19], v[208:211]
    ds_read_b64_tr_b16 a[14:15], v240 offset:22528
    v_cvt_pk_bf16_f32 v159, v190, v191
    v_mfma_f32_16x16x32_bf16 v[212:215], v[72:75], a[16:19], v[212:215]
    ds_write_b64 v163, v[106:107] offset:512
    v_cvt_pk_bf16_f32 v154, v192, v193
    v_mfma_f32_16x16x32_bf16 v[216:219], v[8:11], a[20:23], v[216:219]
    ds_read_b64_tr_b16 a[16:17], v239 offset:24576
    v_cvt_pk_bf16_f32 v155, v194, v195
    v_mfma_f32_16x16x32_bf16 v[220:223], v[40:43], a[20:23], v[220:223]
    ds_read_b64_tr_b16 a[18:19], v239 offset:26624
    v_cvt_pk_bf16_f32 v156, v196, v197
    v_mfma_f32_16x16x32_bf16 v[224:227], v[72:75], a[20:23], v[224:227]
    ds_write_b64 v163, v[112:113] offset:1024
    s_waitcnt lgkmcnt(13)
    v_mfma_f32_16x16x32_bf16 v[204:207], v[12:15], a[24:27], v[204:207]
    ds_read_b64_tr_b16 a[20:21], v240 offset:24576
    v_cvt_pk_bf16_f32 v157, v198, v199
    v_mfma_f32_16x16x32_bf16 v[208:211], v[44:47], a[24:27], v[208:211]
    ds_read_b64_tr_b16 a[22:23], v240 offset:26624
    v_cvt_pk_bf16_f32 v160, v200, v201
    v_mfma_f32_16x16x32_bf16 v[212:215], v[76:79], a[24:27], v[212:215]
    v_cvt_pk_bf16_f32 v161, v202, v203
    v_accvgpr_write_b32 a216, v158
    v_mfma_f32_16x16x32_bf16 a[88:91], v[150:153], v[114:117], 0
    v_accvgpr_write_b32 a217, v159
    v_accvgpr_write_b32 a220, v160
    v_mfma_f32_16x16x32_bf16 a[92:95], v[150:153], v[118:121], 0
    v_accvgpr_write_b32 a221, v161
    s_add_u32 m0, s50, 36864
    v_mfma_f32_16x16x32_bf16 a[96:99], v[150:153], v[122:125], 0
    buffer_load_dwordx4 v228, s[24:27], s48 offen offset:0 lds
    v_mfma_f32_16x16x32_bf16 a[100:103], v[154:157], v[114:117], 0
    v_mfma_f32_16x16x32_bf16 a[104:107], v[154:157], v[118:121], 0
    v_mfma_f32_16x16x32_bf16 a[108:111], v[154:157], v[122:125], 0
    buffer_load_dwordx4 v229, s[24:27], s48 offen offset:1024 lds
    v_mfma_f32_16x16x32_bf16 v[216:219], v[12:15], a[28:31], v[216:219]
    ds_read_b64_tr_b16 a[24:25], v239 offset:28672
    v_mfma_f32_16x16x32_bf16 v[220:223], v[44:47], a[28:31], v[220:223]
    ds_read_b64_tr_b16 a[26:27], v239 offset:30720
    v_mfma_f32_16x16x32_bf16 v[224:227], v[76:79], a[28:31], v[224:227]
    s_waitcnt lgkmcnt(13)
    v_mfma_f32_16x16x32_bf16 v[204:207], v[16:19], a[0:3], v[204:207]
    buffer_load_dwordx4 v230, s[24:27], s48 offen offset:2048 lds
    v_mfma_f32_16x16x32_bf16 v[208:211], v[48:51], a[0:3], v[208:211]
    ds_read_b64_tr_b16 a[28:29], v240 offset:28672
    v_mfma_f32_16x16x32_bf16 v[212:215], v[80:83], a[0:3], v[212:215]
    ds_read_b64_tr_b16 a[30:31], v240 offset:30720
    v_mfma_f32_16x16x32_bf16 v[216:219], v[16:19], a[4:7], v[216:219]
    v_mfma_f32_16x16x32_bf16 v[220:223], v[48:51], a[4:7], v[220:223]
    buffer_load_dwordx4 v231, s[24:27], s48 offen offset:3072 lds
    v_mfma_f32_16x16x32_bf16 v[224:227], v[80:83], a[4:7], v[224:227]
    s_waitcnt lgkmcnt(10)
    v_mfma_f32_16x16x32_bf16 v[204:207], v[20:23], a[8:11], v[204:207]
    v_mfma_f32_16x16x32_bf16 v[208:211], v[52:55], a[8:11], v[208:211]
    v_mfma_f32_16x16x32_bf16 v[212:215], v[84:87], a[8:11], v[212:215]
    s_waitcnt vmcnt(9) lgkmcnt(0)
    s_barrier
    v_mfma_f32_16x16x32_bf16 v[216:219], v[20:23], a[12:15], v[216:219]
    ds_read_b64_tr_b16 a[0:1], v237 offset:0
    s_add_u32 s47, s59, 768
    v_mfma_f32_16x16x32_bf16 v[220:223], v[52:55], a[12:15], v[220:223]
    ds_read_b64_tr_b16 a[2:3], v237 offset:2048
    s_add_u32 s48, s59, 29440
    v_mfma_f32_16x16x32_bf16 v[224:227], v[84:87], a[12:15], v[224:227]
    ds_read_b64_tr_b16 a[4:5], v238 offset:0
    v_mfma_f32_16x16x32_bf16 v[204:207], v[24:27], a[16:19], v[204:207]
    ds_read_b64_tr_b16 a[6:7], v238 offset:2048
    s_add_u32 m0, s50, 65536
    v_mfma_f32_16x16x32_bf16 v[208:211], v[56:59], a[16:19], v[208:211]
    buffer_load_dwordx4 v228, s[24:27], s47 offen offset:0 lds
    v_mfma_f32_16x16x32_bf16 v[212:215], v[88:91], a[16:19], v[212:215]
    ds_read_b64_tr_b16 a[8:9], v237 offset:4096
    v_mfma_f32_16x16x32_bf16 v[216:219], v[24:27], a[20:23], v[216:219]
    ds_read_b64_tr_b16 a[10:11], v237 offset:6144
    v_mfma_f32_16x16x32_bf16 v[220:223], v[56:59], a[20:23], v[220:223]
    ds_read_b64_tr_b16 a[12:13], v238 offset:4096
    v_mfma_f32_16x16x32_bf16 v[224:227], v[88:91], a[20:23], v[224:227]
    ds_read_b64_tr_b16 a[14:15], v238 offset:6144
    v_mfma_f32_16x16x32_bf16 v[204:207], v[28:31], a[24:27], v[204:207]
    ds_read_b64_tr_b16 a[16:17], v237 offset:8192
    v_mfma_f32_16x16x32_bf16 v[208:211], v[60:63], a[24:27], v[208:211]
    buffer_load_dwordx4 v229, s[24:27], s47 offen offset:1024 lds
    v_mfma_f32_16x16x32_bf16 v[212:215], v[92:95], a[24:27], v[212:215]
    ds_read_b64_tr_b16 a[18:19], v237 offset:10240
    v_mfma_f32_16x16x32_bf16 v[216:219], v[28:31], a[28:31], v[216:219]
    ds_read_b64_tr_b16 a[20:21], v238 offset:8192
    v_mfma_f32_16x16x32_bf16 v[220:223], v[60:63], a[28:31], v[220:223]
    ds_read_b64_tr_b16 a[22:23], v238 offset:10240
    v_mfma_f32_16x16x32_bf16 v[224:227], v[92:95], a[28:31], v[224:227]
    ds_read_b64_tr_b16 a[24:25], v237 offset:12288
    s_waitcnt lgkmcnt(9)
    v_mfma_f32_16x16x32_bf16 v[180:183], v[0:3], a[0:3], 0
    ds_read_b64_tr_b16 a[26:27], v237 offset:14336
    v_mfma_f32_16x16x32_bf16 v[184:187], v[32:35], a[0:3], 0
    buffer_load_dwordx4 v230, s[24:27], s47 offen offset:2048 lds
    v_mfma_f32_16x16x32_bf16 v[188:191], v[64:67], a[0:3], 0
    ds_read_b64_tr_b16 a[28:29], v238 offset:12288
    v_mfma_f32_16x16x32_bf16 v[192:195], v[0:3], a[4:7], 0
    ds_read_b64_tr_b16 a[30:31], v238 offset:14336
    v_mfma_f32_16x16x32_bf16 v[196:199], v[32:35], a[4:7], 0
    ds_read_b64_tr_b16 a[0:1], v237 offset:16384
    v_mfma_f32_16x16x32_bf16 v[200:203], v[64:67], a[4:7], 0
    ds_read_b64_tr_b16 a[2:3], v237 offset:18432
    s_waitcnt lgkmcnt(10)
    v_mfma_f32_16x16x32_bf16 v[180:183], v[4:7], a[8:11], v[180:183]
    ds_read_b64_tr_b16 a[4:5], v238 offset:16384
    v_cvt_pk_bf16_f32 v150, v204, v205
    v_mfma_f32_16x16x32_bf16 v[184:187], v[36:39], a[8:11], v[184:187]
    buffer_load_dwordx4 v231, s[24:27], s47 offen offset:3072 lds
    v_mfma_f32_16x16x32_bf16 v[188:191], v[68:71], a[8:11], v[188:191]
    ds_read_b64_tr_b16 a[6:7], v238 offset:18432
    v_cvt_pk_bf16_f32 v151, v206, v207
    v_mfma_f32_16x16x32_bf16 v[192:195], v[4:7], a[12:15], v[192:195]
    ds_read_b64_tr_b16 a[8:9], v237 offset:20480
    v_cvt_pk_bf16_f32 v152, v208, v209
    v_mfma_f32_16x16x32_bf16 v[196:199], v[36:39], a[12:15], v[196:199]
    ds_read_b64_tr_b16 a[10:11], v237 offset:22528
    v_cvt_pk_bf16_f32 v153, v210, v211
    v_mfma_f32_16x16x32_bf16 v[200:203], v[68:71], a[12:15], v[200:203]
    ds_read_b64 v[140:141], v243 offset:0
    s_waitcnt lgkmcnt(11)
    v_mfma_f32_16x16x32_bf16 v[180:183], v[8:11], a[16:19], v[180:183]
    ds_read_b64_tr_b16 a[12:13], v238 offset:20480
    v_cvt_pk_bf16_f32 v158, v212, v213
    v_mfma_f32_16x16x32_bf16 v[184:187], v[40:43], a[16:19], v[184:187]
    ds_read_b64_tr_b16 a[14:15], v238 offset:22528
    v_cvt_pk_bf16_f32 v159, v214, v215
    v_mfma_f32_16x16x32_bf16 v[188:191], v[72:75], a[16:19], v[188:191]
    ds_read_b64 v[144:145], v243 offset:512
    v_cvt_pk_bf16_f32 v154, v216, v217
    v_mfma_f32_16x16x32_bf16 v[192:195], v[8:11], a[20:23], v[192:195]
    ds_read_b64_tr_b16 a[16:17], v237 offset:24576
    v_cvt_pk_bf16_f32 v155, v218, v219
    v_mfma_f32_16x16x32_bf16 v[196:199], v[40:43], a[20:23], v[196:199]
    ds_read_b64_tr_b16 a[18:19], v237 offset:26624
    v_cvt_pk_bf16_f32 v156, v220, v221
    v_mfma_f32_16x16x32_bf16 v[200:203], v[72:75], a[20:23], v[200:203]
    ds_read_b64 v[148:149], v243 offset:1024
    s_waitcnt lgkmcnt(13)
    v_mfma_f32_16x16x32_bf16 v[180:183], v[12:15], a[24:27], v[180:183]
    ds_read_b64_tr_b16 a[20:21], v238 offset:24576
    v_cvt_pk_bf16_f32 v157, v222, v223
    v_mfma_f32_16x16x32_bf16 v[184:187], v[44:47], a[24:27], v[184:187]
    ds_read_b64_tr_b16 a[22:23], v238 offset:26624
    v_cvt_pk_bf16_f32 v160, v224, v225
    v_mfma_f32_16x16x32_bf16 v[188:191], v[76:79], a[24:27], v[188:191]
    ds_read_b128 v[126:129], v242 offset:6144
    v_cvt_pk_bf16_f32 v161, v226, v227
    v_mfma_f32_16x16x32_bf16 a[112:115], v[150:153], v[114:117], 0
    ds_read_b128 v[130:133], v242 offset:7168
    v_accvgpr_write_b32 a224, v158
    v_mfma_f32_16x16x32_bf16 a[116:119], v[150:153], v[118:121], 0
    ds_read_b128 v[134:137], v242 offset:8192
    v_accvgpr_write_b32 a225, v159
    v_mfma_f32_16x16x32_bf16 a[120:123], v[150:153], v[122:125], 0
    v_accvgpr_write_b32 a228, v160
    v_accvgpr_write_b32 a229, v161
    v_mfma_f32_16x16x32_bf16 a[124:127], v[154:157], v[114:117], 0
    s_add_u32 m0, s50, 69632
    v_mfma_f32_16x16x32_bf16 a[128:131], v[154:157], v[118:121], 0
    buffer_load_dwordx4 v228, s[24:27], s48 offen offset:0 lds
    v_mfma_f32_16x16x32_bf16 a[132:135], v[154:157], v[122:125], 0
    v_mfma_f32_16x16x32_bf16 v[192:195], v[12:15], a[28:31], v[192:195]
    ds_read_b64_tr_b16 a[24:25], v237 offset:28672
    v_mfma_f32_16x16x32_bf16 v[196:199], v[44:47], a[28:31], v[196:199]
    buffer_load_dwordx4 v229, s[24:27], s48 offen offset:1024 lds
    v_mfma_f32_16x16x32_bf16 v[200:203], v[76:79], a[28:31], v[200:203]
    ds_read_b64_tr_b16 a[26:27], v237 offset:30720
    s_waitcnt lgkmcnt(15)
    v_mfma_f32_16x16x32_bf16 v[180:183], v[16:19], a[0:3], v[180:183]
    ds_read_b64_tr_b16 a[28:29], v238 offset:28672
    v_mfma_f32_16x16x32_bf16 v[184:187], v[48:51], a[0:3], v[184:187]
    buffer_load_dwordx4 v230, s[24:27], s48 offen offset:2048 lds
    v_mfma_f32_16x16x32_bf16 v[188:191], v[80:83], a[0:3], v[188:191]
    ds_read_b64_tr_b16 a[30:31], v238 offset:30720
    v_mfma_f32_16x16x32_bf16 v[192:195], v[16:19], a[4:7], v[192:195]
    v_mfma_f32_16x16x32_bf16 v[196:199], v[48:51], a[4:7], v[196:199]
    buffer_load_dwordx4 v231, s[24:27], s48 offen offset:3072 lds
    v_mfma_f32_16x16x32_bf16 v[200:203], v[80:83], a[4:7], v[200:203]
    s_waitcnt lgkmcnt(13)
    v_mfma_f32_16x16x32_bf16 v[180:183], v[20:23], a[8:11], v[180:183]
    v_mfma_f32_16x16x32_bf16 v[184:187], v[52:55], a[8:11], v[184:187]
    v_mfma_f32_16x16x32_bf16 v[188:191], v[84:87], a[8:11], v[188:191]
    s_waitcnt vmcnt(8) lgkmcnt(0)
    s_barrier
    v_mfma_f32_16x16x32_bf16 v[192:195], v[20:23], a[12:15], v[192:195]
    ds_read_b64_tr_b16 a[0:1], v237 offset:32768
    s_add_u32 s47, s59, 229376
    v_mfma_f32_16x16x32_bf16 v[196:199], v[52:55], a[12:15], v[196:199]
    ds_read_b64_tr_b16 a[2:3], v237 offset:34816
    s_add_u32 s48, s59, 258048
    v_mfma_f32_16x16x32_bf16 v[200:203], v[84:87], a[12:15], v[200:203]
    ds_read_b64_tr_b16 a[4:5], v238 offset:32768
    v_mfma_f32_16x16x32_bf16 v[180:183], v[24:27], a[16:19], v[180:183]
    ds_read_b64_tr_b16 a[6:7], v238 offset:34816
    s_add_u32 m0, s50, 0
    v_mfma_f32_16x16x32_bf16 v[184:187], v[56:59], a[16:19], v[184:187]
    buffer_load_dwordx4 v228, s[24:27], s47 offen offset:0 lds
    v_mfma_f32_16x16x32_bf16 v[188:191], v[88:91], a[16:19], v[188:191]
    ds_read_b64_tr_b16 a[8:9], v237 offset:36864
    s_add_u32 s49, s58, 24832
    v_mfma_f32_16x16x32_bf16 v[192:195], v[24:27], a[20:23], v[192:195]
    ds_read_b64_tr_b16 a[10:11], v237 offset:38912
    v_mfma_f32_16x16x32_bf16 v[196:199], v[56:59], a[20:23], v[196:199]
    buffer_load_dwordx4 v229, s[24:27], s47 offen offset:1024 lds
    v_mfma_f32_16x16x32_bf16 v[200:203], v[88:91], a[20:23], v[200:203]
    ds_read_b64_tr_b16 a[12:13], v238 offset:36864
    v_mfma_f32_16x16x32_bf16 v[180:183], v[28:31], a[24:27], v[180:183]
    ds_read_b64_tr_b16 a[14:15], v238 offset:38912
    v_mfma_f32_16x16x32_bf16 v[184:187], v[60:63], a[24:27], v[184:187]
    buffer_load_dwordx4 v230, s[24:27], s47 offen offset:2048 lds
    v_mfma_f32_16x16x32_bf16 v[188:191], v[92:95], a[24:27], v[188:191]
    ds_read_b64_tr_b16 a[16:17], v237 offset:40960
    v_mfma_f32_16x16x32_bf16 v[192:195], v[28:31], a[28:31], v[192:195]
    ds_read_b64_tr_b16 a[18:19], v237 offset:43008
    v_mfma_f32_16x16x32_bf16 v[196:199], v[60:63], a[28:31], v[196:199]
    buffer_load_dwordx4 v231, s[24:27], s47 offen offset:3072 lds
    v_mfma_f32_16x16x32_bf16 v[200:203], v[92:95], a[28:31], v[200:203]
    ds_read_b64_tr_b16 a[20:21], v238 offset:40960
    s_waitcnt lgkmcnt(7)
    v_mfma_f32_16x16x32_bf16 v[204:207], v[0:3], a[0:3], 0
    ds_read_b64_tr_b16 a[22:23], v238 offset:43008
    s_add_u32 m0, s50, 4096
    v_mfma_f32_16x16x32_bf16 v[208:211], v[32:35], a[0:3], 0
    buffer_load_dwordx4 v228, s[24:27], s48 offen offset:0 lds
    v_mfma_f32_16x16x32_bf16 v[212:215], v[64:67], a[0:3], 0
    ds_read_b64_tr_b16 a[24:25], v237 offset:45056
    v_mfma_f32_16x16x32_bf16 v[216:219], v[0:3], a[4:7], 0
    ds_read_b64_tr_b16 a[26:27], v237 offset:47104
    v_mfma_f32_16x16x32_bf16 v[220:223], v[32:35], a[4:7], 0
    buffer_load_dwordx4 v229, s[24:27], s48 offen offset:1024 lds
    v_mfma_f32_16x16x32_bf16 v[224:227], v[64:67], a[4:7], 0
    ds_read_b64_tr_b16 a[28:29], v238 offset:45056
    s_waitcnt lgkmcnt(7)
    v_mfma_f32_16x16x32_bf16 v[204:207], v[4:7], a[8:11], v[204:207]
    ds_read_b64_tr_b16 a[30:31], v238 offset:47104
    v_cvt_pk_bf16_f32 v150, v180, v181
    v_mfma_f32_16x16x32_bf16 v[208:211], v[36:39], a[8:11], v[208:211]
    buffer_load_dwordx4 v230, s[24:27], s48 offen offset:2048 lds
    v_mfma_f32_16x16x32_bf16 v[212:215], v[68:71], a[8:11], v[212:215]
    ds_read_b64_tr_b16 a[0:1], v237 offset:49152
    v_cvt_pk_bf16_f32 v151, v182, v183
    v_mfma_f32_16x16x32_bf16 v[216:219], v[4:7], a[12:15], v[216:219]
    ds_read_b64_tr_b16 a[2:3], v237 offset:51200
    v_cvt_pk_bf16_f32 v152, v184, v185
    v_mfma_f32_16x16x32_bf16 v[220:223], v[36:39], a[12:15], v[220:223]
    buffer_load_dwordx4 v231, s[24:27], s48 offen offset:3072 lds
    v_mfma_f32_16x16x32_bf16 v[224:227], v[68:71], a[12:15], v[224:227]
    ds_read_b64_tr_b16 a[4:5], v238 offset:49152
    s_waitcnt lgkmcnt(7)
    v_mfma_f32_16x16x32_bf16 v[204:207], v[8:11], a[16:19], v[204:207]
    ds_read_b64_tr_b16 a[6:7], v238 offset:51200
    v_cvt_pk_bf16_f32 v153, v186, v187
    v_mfma_f32_16x16x32_bf16 v[208:211], v[40:43], a[16:19], v[208:211]
    ds_read_b64_tr_b16 a[8:9], v237 offset:53248
    v_cvt_pk_bf16_f32 v158, v188, v189
    v_mfma_f32_16x16x32_bf16 v[212:215], v[72:75], a[16:19], v[212:215]
    ds_read_b64_tr_b16 a[10:11], v237 offset:55296
    v_cvt_pk_bf16_f32 v159, v190, v191
    v_mfma_f32_16x16x32_bf16 v[216:219], v[8:11], a[20:23], v[216:219]
    ds_read_b64_tr_b16 a[12:13], v238 offset:53248
    v_cvt_pk_bf16_f32 v154, v192, v193
    v_mfma_f32_16x16x32_bf16 v[220:223], v[40:43], a[20:23], v[220:223]
    ds_read_b64_tr_b16 a[14:15], v238 offset:55296
    v_cvt_pk_bf16_f32 v155, v194, v195
    v_mfma_f32_16x16x32_bf16 v[224:227], v[72:75], a[20:23], v[224:227]
    ds_read_b64_tr_b16 a[16:17], v237 offset:57344
    s_waitcnt lgkmcnt(9)
    v_mfma_f32_16x16x32_bf16 v[204:207], v[12:15], a[24:27], v[204:207]
    ds_read_b64_tr_b16 a[18:19], v237 offset:59392
    v_cvt_pk_bf16_f32 v156, v196, v197
    v_mfma_f32_16x16x32_bf16 v[208:211], v[44:47], a[24:27], v[208:211]
    ds_read_b64_tr_b16 a[20:21], v238 offset:57344
    v_cvt_pk_bf16_f32 v157, v198, v199
    v_mfma_f32_16x16x32_bf16 v[212:215], v[76:79], a[24:27], v[212:215]
    ds_read_b64_tr_b16 a[22:23], v238 offset:59392
    v_cvt_pk_bf16_f32 v160, v200, v201
    v_mfma_f32_16x16x32_bf16 a[136:139], v[150:153], v[114:117], 0
    v_cvt_pk_bf16_f32 v161, v202, v203
    v_accvgpr_write_b32 a232, v158
    v_mfma_f32_16x16x32_bf16 a[140:143], v[150:153], v[118:121], 0
    v_accvgpr_write_b32 a233, v159
    v_accvgpr_write_b32 a236, v160
    v_mfma_f32_16x16x32_bf16 a[144:147], v[150:153], v[122:125], 0
    v_accvgpr_write_b32 a237, v161
    s_add_u32 m0, s51, 4096
    v_mfma_f32_16x16x32_bf16 a[148:151], v[154:157], v[114:117], 0
    buffer_load_dwordx4 v232, s[16:19], s49 offen nt lds
    v_mfma_f32_16x16x32_bf16 a[152:155], v[154:157], v[118:121], 0
    s_add_u32 s49, s58, 33024
    s_add_u32 m0, s51, 12288
    v_mfma_f32_16x16x32_bf16 a[156:159], v[154:157], v[122:125], 0
    buffer_load_dwordx4 v232, s[16:19], s49 offen nt lds
    v_mfma_f32_16x16x32_bf16 v[216:219], v[12:15], a[28:31], v[216:219]
    ds_read_b64_tr_b16 a[24:25], v237 offset:61440
    s_add_u32 s49, s58, 41216
    v_mfma_f32_16x16x32_bf16 v[220:223], v[44:47], a[28:31], v[220:223]
    ds_read_b64_tr_b16 a[26:27], v237 offset:63488
    s_add_u32 m0, s51, 20480
    v_mfma_f32_16x16x32_bf16 v[224:227], v[76:79], a[28:31], v[224:227]
    s_waitcnt lgkmcnt(10)
    v_mfma_f32_16x16x32_bf16 v[204:207], v[16:19], a[0:3], v[204:207]
    buffer_load_dwordx4 v232, s[16:19], s49 offen nt lds
    v_mfma_f32_16x16x32_bf16 v[208:211], v[48:51], a[0:3], v[208:211]
    ds_read_b64_tr_b16 a[28:29], v238 offset:61440
    s_add_u32 s49, s58, 418048
    v_mfma_f32_16x16x32_bf16 v[212:215], v[80:83], a[0:3], v[212:215]
    ds_read_b64_tr_b16 a[30:31], v238 offset:63488
    s_add_u32 m0, s51, 28672
    v_mfma_f32_16x16x32_bf16 v[216:219], v[16:19], a[4:7], v[216:219]
    buffer_load_dwordx4 v232, s[16:19], s49 offen nt lds
    v_mfma_f32_16x16x32_bf16 v[220:223], v[48:51], a[4:7], v[220:223]
    s_add_u32 s49, s58, 426240
    s_add_u32 m0, s51, 36864
    v_mfma_f32_16x16x32_bf16 v[224:227], v[80:83], a[4:7], v[224:227]
    s_waitcnt lgkmcnt(8)
    v_mfma_f32_16x16x32_bf16 v[204:207], v[20:23], a[8:11], v[204:207]
    buffer_load_dwordx4 v232, s[16:19], s49 offen nt lds
    v_mfma_f32_16x16x32_bf16 v[208:211], v[52:55], a[8:11], v[208:211]
    s_add_u32 s49, s58, 434432
    s_add_u32 m0, s51, 45056
    v_mfma_f32_16x16x32_bf16 v[212:215], v[84:87], a[8:11], v[212:215]
    buffer_load_dwordx4 v232, s[16:19], s49 offen nt lds
    s_waitcnt vmcnt(14) lgkmcnt(0)
    s_barrier
    v_mfma_f32_16x16x32_bf16 v[216:219], v[20:23], a[12:15], v[216:219]
    ds_read_b64_tr_b16 a[0:1], v239 offset:0
    s_add_u32 s47, s59, 229504
    v_mfma_f32_16x16x32_bf16 v[220:223], v[52:55], a[12:15], v[220:223]
    ds_read_b64_tr_b16 a[2:3], v239 offset:2048
    s_add_u32 s48, s59, 258176
    v_mfma_f32_16x16x32_bf16 v[224:227], v[84:87], a[12:15], v[224:227]
    ds_read_b64_tr_b16 a[4:5], v240 offset:0
    v_mfma_f32_16x16x32_bf16 v[204:207], v[24:27], a[16:19], v[204:207]
    ds_read_b64_tr_b16 a[6:7], v240 offset:2048
    s_add_u32 m0, s50, 32768
    v_mfma_f32_16x16x32_bf16 v[208:211], v[56:59], a[16:19], v[208:211]
    ds_read_b64_tr_b16 a[8:9], v239 offset:4096
    v_mfma_f32_16x16x32_bf16 v[212:215], v[88:91], a[16:19], v[212:215]
    buffer_load_dwordx4 v228, s[24:27], s47 offen offset:0 lds
    v_mfma_f32_16x16x32_bf16 v[216:219], v[24:27], a[20:23], v[216:219]
    ds_read_b64_tr_b16 a[10:11], v239 offset:6144
    v_mfma_f32_16x16x32_bf16 v[220:223], v[56:59], a[20:23], v[220:223]
    ds_read_b64_tr_b16 a[12:13], v240 offset:4096
    v_mfma_f32_16x16x32_bf16 v[224:227], v[88:91], a[20:23], v[224:227]
    ds_read_b64_tr_b16 a[14:15], v240 offset:6144
    v_mfma_f32_16x16x32_bf16 v[204:207], v[28:31], a[24:27], v[204:207]
    ds_read_b64_tr_b16 a[16:17], v239 offset:8192
    v_mfma_f32_16x16x32_bf16 v[208:211], v[60:63], a[24:27], v[208:211]
    ds_read_b64_tr_b16 a[18:19], v239 offset:10240
    v_mfma_f32_16x16x32_bf16 v[212:215], v[92:95], a[24:27], v[212:215]
    buffer_load_dwordx4 v229, s[24:27], s47 offen offset:1024 lds
    v_mfma_f32_16x16x32_bf16 v[216:219], v[28:31], a[28:31], v[216:219]
    ds_read_b64_tr_b16 a[20:21], v240 offset:8192
    v_mfma_f32_16x16x32_bf16 v[220:223], v[60:63], a[28:31], v[220:223]
    ds_read_b64_tr_b16 a[22:23], v240 offset:10240
    v_mfma_f32_16x16x32_bf16 v[224:227], v[92:95], a[28:31], v[224:227]
    ds_read_b64_tr_b16 a[24:25], v239 offset:12288
    s_waitcnt lgkmcnt(9)
    v_mfma_f32_16x16x32_bf16 v[180:183], v[0:3], a[0:3], 0
    ds_read_b64_tr_b16 a[26:27], v239 offset:14336
    v_mfma_f32_16x16x32_bf16 v[184:187], v[32:35], a[0:3], 0
    ds_read_b64_tr_b16 a[28:29], v240 offset:12288
    v_mfma_f32_16x16x32_bf16 v[188:191], v[64:67], a[0:3], 0
    buffer_load_dwordx4 v230, s[24:27], s47 offen offset:2048 lds
    v_mfma_f32_16x16x32_bf16 v[192:195], v[0:3], a[4:7], 0
    ds_read_b64_tr_b16 a[30:31], v240 offset:14336
    v_mfma_f32_16x16x32_bf16 v[196:199], v[32:35], a[4:7], 0
    ds_read_b64_tr_b16 a[0:1], v239 offset:16384
    v_mfma_f32_16x16x32_bf16 v[200:203], v[64:67], a[4:7], 0
    ds_read_b64_tr_b16 a[2:3], v239 offset:18432
    s_waitcnt lgkmcnt(10)
    v_mfma_f32_16x16x32_bf16 v[180:183], v[4:7], a[8:11], v[180:183]
    ds_read_b64_tr_b16 a[4:5], v240 offset:16384
    v_cvt_pk_bf16_f32 v150, v204, v205
    v_mfma_f32_16x16x32_bf16 v[184:187], v[36:39], a[8:11], v[184:187]
    ds_read_b64_tr_b16 a[6:7], v240 offset:18432
    v_cvt_pk_bf16_f32 v151, v206, v207
    v_mfma_f32_16x16x32_bf16 v[188:191], v[68:71], a[8:11], v[188:191]
    buffer_load_dwordx4 v231, s[24:27], s47 offen offset:3072 lds
    v_mfma_f32_16x16x32_bf16 v[192:195], v[4:7], a[12:15], v[192:195]
    ds_read_b64_tr_b16 a[8:9], v239 offset:20480
    v_cvt_pk_bf16_f32 v152, v208, v209
    v_mfma_f32_16x16x32_bf16 v[196:199], v[36:39], a[12:15], v[196:199]
    ds_read_b64_tr_b16 a[10:11], v239 offset:22528
    v_cvt_pk_bf16_f32 v153, v210, v211
    v_mfma_f32_16x16x32_bf16 v[200:203], v[68:71], a[12:15], v[200:203]
    ds_read_b128 v[0:3], v233 offset:0
    s_waitcnt lgkmcnt(11)
    v_mfma_f32_16x16x32_bf16 v[180:183], v[8:11], a[16:19], v[180:183]
    ds_read_b64_tr_b16 a[12:13], v240 offset:20480
    v_cvt_pk_bf16_f32 v158, v212, v213
    v_mfma_f32_16x16x32_bf16 v[184:187], v[40:43], a[16:19], v[184:187]
    ds_read_b64_tr_b16 a[14:15], v240 offset:22528
    v_cvt_pk_bf16_f32 v159, v214, v215
    v_mfma_f32_16x16x32_bf16 v[188:191], v[72:75], a[16:19], v[188:191]
    ds_read_b128 v[32:35], v233 offset:8192
    v_cvt_pk_bf16_f32 v154, v216, v217
    v_mfma_f32_16x16x32_bf16 v[192:195], v[8:11], a[20:23], v[192:195]
    ds_read_b64_tr_b16 a[16:17], v239 offset:24576
    v_cvt_pk_bf16_f32 v155, v218, v219
    v_mfma_f32_16x16x32_bf16 v[196:199], v[40:43], a[20:23], v[196:199]
    ds_read_b64_tr_b16 a[18:19], v239 offset:26624
    v_cvt_pk_bf16_f32 v156, v220, v221
    v_mfma_f32_16x16x32_bf16 v[200:203], v[72:75], a[20:23], v[200:203]
    ds_read_b128 v[64:67], v233 offset:16384
    s_waitcnt lgkmcnt(13)
    v_mfma_f32_16x16x32_bf16 v[180:183], v[12:15], a[24:27], v[180:183]
    ds_read_b64_tr_b16 a[20:21], v240 offset:24576
    v_cvt_pk_bf16_f32 v157, v222, v223
    v_mfma_f32_16x16x32_bf16 v[184:187], v[44:47], a[24:27], v[184:187]
    ds_read_b64_tr_b16 a[22:23], v240 offset:26624
    v_cvt_pk_bf16_f32 v160, v224, v225
    v_mfma_f32_16x16x32_bf16 v[188:191], v[76:79], a[24:27], v[188:191]
    ds_read_b128 v[4:7], v234 offset:0
    v_cvt_pk_bf16_f32 v161, v226, v227
    v_mfma_f32_16x16x32_bf16 a[160:163], v[150:153], v[114:117], 0
    ds_read_b128 v[36:39], v234 offset:8192
    v_accvgpr_write_b32 a240, v158
    v_mfma_f32_16x16x32_bf16 a[164:167], v[150:153], v[118:121], 0
    ds_read_b128 v[68:71], v234 offset:16384
    v_accvgpr_write_b32 a241, v159
    v_mfma_f32_16x16x32_bf16 a[168:171], v[150:153], v[122:125], 0
    ds_read_b128 v[8:11], v235 offset:0
    v_accvgpr_write_b32 a244, v160
    v_mfma_f32_16x16x32_bf16 a[172:175], v[154:157], v[114:117], 0
    ds_read_b128 v[40:43], v235 offset:8192
    v_accvgpr_write_b32 a245, v161
    v_mfma_f32_16x16x32_bf16 a[176:179], v[154:157], v[118:121], 0
    ds_read_b128 v[72:75], v235 offset:16384
    s_add_u32 m0, s50, 36864
    v_mfma_f32_16x16x32_bf16 a[180:183], v[154:157], v[122:125], 0
    buffer_load_dwordx4 v228, s[24:27], s48 offen offset:0 lds
    v_mfma_f32_16x16x32_bf16 v[192:195], v[12:15], a[28:31], v[192:195]
    ds_read_b64_tr_b16 a[24:25], v239 offset:28672
    v_mfma_f32_16x16x32_bf16 v[196:199], v[44:47], a[28:31], v[196:199]
    ds_read_b64_tr_b16 a[26:27], v239 offset:30720
    v_mfma_f32_16x16x32_bf16 v[200:203], v[76:79], a[28:31], v[200:203]
    s_waitcnt lgkmcnt(15)
    v_mfma_f32_16x16x32_bf16 v[180:183], v[16:19], a[0:3], v[180:183]
    buffer_load_dwordx4 v229, s[24:27], s48 offen offset:1024 lds
    v_mfma_f32_16x16x32_bf16 v[184:187], v[48:51], a[0:3], v[184:187]
    ds_read_b64_tr_b16 a[28:29], v240 offset:28672
    v_mfma_f32_16x16x32_bf16 v[188:191], v[80:83], a[0:3], v[188:191]
    buffer_load_dwordx4 v230, s[24:27], s48 offen offset:2048 lds
    v_mfma_f32_16x16x32_bf16 v[192:195], v[16:19], a[4:7], v[192:195]
    ds_read_b64_tr_b16 a[30:31], v240 offset:30720
    v_mfma_f32_16x16x32_bf16 v[196:199], v[48:51], a[4:7], v[196:199]
    ds_read_b128 v[12:15], v236 offset:0
    v_mfma_f32_16x16x32_bf16 v[200:203], v[80:83], a[4:7], v[200:203]
    ds_read_b128 v[44:47], v236 offset:8192
    s_waitcnt lgkmcnt(15)
    v_mfma_f32_16x16x32_bf16 v[180:183], v[20:23], a[8:11], v[180:183]
    buffer_load_dwordx4 v231, s[24:27], s48 offen offset:3072 lds
    v_mfma_f32_16x16x32_bf16 v[184:187], v[52:55], a[8:11], v[184:187]
    ds_read_b128 v[76:79], v236 offset:16384
    v_mfma_f32_16x16x32_bf16 v[188:191], v[84:87], a[8:11], v[188:191]
    s_waitcnt vmcnt(8) lgkmcnt(0)
    s_barrier
    v_mfma_f32_16x16x32_bf16 v[192:195], v[20:23], a[12:15], v[192:195]
    ds_read_b64_tr_b16 a[0:1], v237 offset:0
    s_add_u32 s47, s59, 229632
    v_mfma_f32_16x16x32_bf16 v[196:199], v[52:55], a[12:15], v[196:199]
    ds_read_b64_tr_b16 a[2:3], v237 offset:2048
    s_add_u32 s48, s59, 258304
    v_mfma_f32_16x16x32_bf16 v[200:203], v[84:87], a[12:15], v[200:203]
    ds_read_b64_tr_b16 a[4:5], v238 offset:0
    v_mfma_f32_16x16x32_bf16 v[180:183], v[24:27], a[16:19], v[180:183]
    ds_read_b64_tr_b16 a[6:7], v238 offset:2048
    s_add_u32 m0, s50, 65536
    v_mfma_f32_16x16x32_bf16 v[184:187], v[56:59], a[16:19], v[184:187]
    buffer_load_dwordx4 v228, s[24:27], s47 offen offset:0 lds
    v_mfma_f32_16x16x32_bf16 v[188:191], v[88:91], a[16:19], v[188:191]
    ds_read_b64_tr_b16 a[8:9], v237 offset:4096
    v_mfma_f32_16x16x32_bf16 v[192:195], v[24:27], a[20:23], v[192:195]
    ds_read_b64_tr_b16 a[10:11], v237 offset:6144
    v_mfma_f32_16x16x32_bf16 v[196:199], v[56:59], a[20:23], v[196:199]
    ds_read_b64_tr_b16 a[12:13], v238 offset:4096
    v_mfma_f32_16x16x32_bf16 v[200:203], v[88:91], a[20:23], v[200:203]
    ds_read_b64_tr_b16 a[14:15], v238 offset:6144
    v_mfma_f32_16x16x32_bf16 v[180:183], v[28:31], a[24:27], v[180:183]
    ds_read_b64_tr_b16 a[16:17], v237 offset:8192
    v_mfma_f32_16x16x32_bf16 v[184:187], v[60:63], a[24:27], v[184:187]
    buffer_load_dwordx4 v229, s[24:27], s47 offen offset:1024 lds
    v_mfma_f32_16x16x32_bf16 v[188:191], v[92:95], a[24:27], v[188:191]
    ds_read_b64_tr_b16 a[18:19], v237 offset:10240
    v_mfma_f32_16x16x32_bf16 v[192:195], v[28:31], a[28:31], v[192:195]
    ds_read_b64_tr_b16 a[20:21], v238 offset:8192
    v_mfma_f32_16x16x32_bf16 v[196:199], v[60:63], a[28:31], v[196:199]
    ds_read_b64_tr_b16 a[22:23], v238 offset:10240
    v_mfma_f32_16x16x32_bf16 v[200:203], v[92:95], a[28:31], v[200:203]
    ds_read_b64_tr_b16 a[24:25], v237 offset:12288
    s_waitcnt lgkmcnt(9)
    v_mfma_f32_16x16x32_bf16 v[204:207], v[0:3], a[0:3], 0
    ds_read_b64_tr_b16 a[26:27], v237 offset:14336
    v_mfma_f32_16x16x32_bf16 v[208:211], v[32:35], a[0:3], 0
    buffer_load_dwordx4 v230, s[24:27], s47 offen offset:2048 lds
    v_mfma_f32_16x16x32_bf16 v[212:215], v[64:67], a[0:3], 0
    ds_read_b64_tr_b16 a[28:29], v238 offset:12288
    v_mfma_f32_16x16x32_bf16 v[216:219], v[0:3], a[4:7], 0
    ds_read_b64_tr_b16 a[30:31], v238 offset:14336
    v_mfma_f32_16x16x32_bf16 v[220:223], v[32:35], a[4:7], 0
    ds_read_b64_tr_b16 a[0:1], v237 offset:16384
    v_mfma_f32_16x16x32_bf16 v[224:227], v[64:67], a[4:7], 0
    ds_read_b64_tr_b16 a[2:3], v237 offset:18432
    s_waitcnt lgkmcnt(10)
    v_mfma_f32_16x16x32_bf16 v[204:207], v[4:7], a[8:11], v[204:207]
    ds_read_b64_tr_b16 a[4:5], v238 offset:16384
    v_cvt_pk_bf16_f32 v150, v180, v181
    v_mfma_f32_16x16x32_bf16 v[208:211], v[36:39], a[8:11], v[208:211]
    buffer_load_dwordx4 v231, s[24:27], s47 offen offset:3072 lds
    v_mfma_f32_16x16x32_bf16 v[212:215], v[68:71], a[8:11], v[212:215]
    ds_read_b64_tr_b16 a[6:7], v238 offset:18432
    v_cvt_pk_bf16_f32 v151, v182, v183
    v_mfma_f32_16x16x32_bf16 v[216:219], v[4:7], a[12:15], v[216:219]
    ds_read_b64_tr_b16 a[8:9], v237 offset:20480
    v_cvt_pk_bf16_f32 v152, v184, v185
    v_mfma_f32_16x16x32_bf16 v[220:223], v[36:39], a[12:15], v[220:223]
    ds_read_b64_tr_b16 a[10:11], v237 offset:22528
    v_cvt_pk_bf16_f32 v153, v186, v187
    v_mfma_f32_16x16x32_bf16 v[224:227], v[68:71], a[12:15], v[224:227]
    ds_read_b128 v[16:19], v233 offset:4096
    s_waitcnt lgkmcnt(11)
    v_mfma_f32_16x16x32_bf16 v[204:207], v[8:11], a[16:19], v[204:207]
    ds_read_b64_tr_b16 a[12:13], v238 offset:20480
    v_cvt_pk_bf16_f32 v158, v188, v189
    v_mfma_f32_16x16x32_bf16 v[208:211], v[40:43], a[16:19], v[208:211]
    ds_read_b64_tr_b16 a[14:15], v238 offset:22528
    v_cvt_pk_bf16_f32 v159, v190, v191
    v_mfma_f32_16x16x32_bf16 v[212:215], v[72:75], a[16:19], v[212:215]
    ds_read_b128 v[48:51], v233 offset:12288
    v_cvt_pk_bf16_f32 v154, v192, v193
    v_mfma_f32_16x16x32_bf16 v[216:219], v[8:11], a[20:23], v[216:219]
    ds_read_b64_tr_b16 a[16:17], v237 offset:24576
    v_cvt_pk_bf16_f32 v155, v194, v195
    v_mfma_f32_16x16x32_bf16 v[220:223], v[40:43], a[20:23], v[220:223]
    ds_read_b64_tr_b16 a[18:19], v237 offset:26624
    v_cvt_pk_bf16_f32 v156, v196, v197
    v_mfma_f32_16x16x32_bf16 v[224:227], v[72:75], a[20:23], v[224:227]
    ds_read_b128 v[80:83], v233 offset:20480
    s_waitcnt lgkmcnt(13)
    v_mfma_f32_16x16x32_bf16 v[204:207], v[12:15], a[24:27], v[204:207]
    ds_read_b64_tr_b16 a[20:21], v238 offset:24576
    v_cvt_pk_bf16_f32 v157, v198, v199
    v_mfma_f32_16x16x32_bf16 v[208:211], v[44:47], a[24:27], v[208:211]
    ds_read_b64_tr_b16 a[22:23], v238 offset:26624
    v_cvt_pk_bf16_f32 v160, v200, v201
    v_mfma_f32_16x16x32_bf16 v[212:215], v[76:79], a[24:27], v[212:215]
    ds_read_b128 v[20:23], v234 offset:4096
    v_cvt_pk_bf16_f32 v161, v202, v203
    v_mfma_f32_16x16x32_bf16 a[184:187], v[150:153], v[114:117], 0
    ds_read_b128 v[52:55], v234 offset:12288
    v_accvgpr_write_b32 a248, v158
    v_mfma_f32_16x16x32_bf16 a[188:191], v[150:153], v[118:121], 0
    ds_read_b128 v[84:87], v234 offset:20480
    v_accvgpr_write_b32 a249, v159
    v_mfma_f32_16x16x32_bf16 a[192:195], v[150:153], v[122:125], 0
    ds_read_b128 v[24:27], v235 offset:4096
    v_accvgpr_write_b32 a252, v160
    v_mfma_f32_16x16x32_bf16 a[196:199], v[154:157], v[114:117], 0
    ds_read_b128 v[56:59], v235 offset:12288
    v_accvgpr_write_b32 a253, v161
    v_mfma_f32_16x16x32_bf16 a[200:203], v[154:157], v[118:121], 0
    ds_read_b128 v[88:91], v235 offset:20480
    s_add_u32 m0, s50, 69632
    v_mfma_f32_16x16x32_bf16 a[204:207], v[154:157], v[122:125], 0
    buffer_load_dwordx4 v228, s[24:27], s48 offen offset:0 lds
    v_mfma_f32_16x16x32_bf16 v[216:219], v[12:15], a[28:31], v[216:219]
    ds_read_b64_tr_b16 a[24:25], v237 offset:28672
    v_mfma_f32_16x16x32_bf16 v[220:223], v[44:47], a[28:31], v[220:223]
    ds_read_b64_tr_b16 a[26:27], v237 offset:30720
    v_mfma_f32_16x16x32_bf16 v[224:227], v[76:79], a[28:31], v[224:227]
    ds_read_b128 v[28:31], v236 offset:4096
    s_waitcnt lgkmcnt(15)
    v_mfma_f32_16x16x32_bf16 v[204:207], v[16:19], a[0:3], v[204:207]
    buffer_load_dwordx4 v229, s[24:27], s48 offen offset:1024 lds
    s_waitcnt lgkmcnt(14)
    v_mfma_f32_16x16x32_bf16 v[208:211], v[48:51], a[0:3], v[208:211]
    ds_read_b64_tr_b16 a[28:29], v238 offset:28672
    s_waitcnt lgkmcnt(12)
    v_mfma_f32_16x16x32_bf16 v[212:215], v[80:83], a[0:3], v[212:215]
    buffer_load_dwordx4 v230, s[24:27], s48 offen offset:2048 lds
    v_mfma_f32_16x16x32_bf16 v[216:219], v[16:19], a[4:7], v[216:219]
    ds_read_b64_tr_b16 a[30:31], v238 offset:30720
    v_mfma_f32_16x16x32_bf16 v[220:223], v[48:51], a[4:7], v[220:223]
    ds_read_b128 v[60:63], v236 offset:12288
    v_mfma_f32_16x16x32_bf16 v[224:227], v[80:83], a[4:7], v[224:227]
    ds_read_b128 v[92:95], v236 offset:20480
    s_waitcnt lgkmcnt(12)
    v_mfma_f32_16x16x32_bf16 v[204:207], v[20:23], a[8:11], v[204:207]
    buffer_load_dwordx4 v231, s[24:27], s48 offen offset:3072 lds
    s_waitcnt lgkmcnt(11)
    v_mfma_f32_16x16x32_bf16 v[208:211], v[52:55], a[8:11], v[208:211]
    s_waitcnt lgkmcnt(10)
    v_mfma_f32_16x16x32_bf16 v[212:215], v[84:87], a[8:11], v[212:215]
    s_waitcnt vmcnt(8) lgkmcnt(0)
    s_barrier
    v_mfma_f32_16x16x32_bf16 v[216:219], v[20:23], a[12:15], v[216:219]
    ds_read_b64_tr_b16 a[0:1], v237 offset:32768
    s_add_u32 s47, s59, 229760
    v_mfma_f32_16x16x32_bf16 v[220:223], v[52:55], a[12:15], v[220:223]
    ds_read_b64_tr_b16 a[2:3], v237 offset:34816
    s_add_u32 s48, s59, 258432
    v_mfma_f32_16x16x32_bf16 v[224:227], v[84:87], a[12:15], v[224:227]
    ds_read_b64_tr_b16 a[4:5], v238 offset:32768
    v_mfma_f32_16x16x32_bf16 v[204:207], v[24:27], a[16:19], v[204:207]
    ds_read_b64_tr_b16 a[6:7], v238 offset:34816
    s_add_u32 m0, s50, 0
    v_mfma_f32_16x16x32_bf16 v[208:211], v[56:59], a[16:19], v[208:211]
    buffer_load_dwordx4 v228, s[24:27], s47 offen offset:0 lds
    v_mfma_f32_16x16x32_bf16 v[212:215], v[88:91], a[16:19], v[212:215]
    ds_read_b64_tr_b16 a[8:9], v237 offset:36864
    v_mfma_f32_16x16x32_bf16 v[216:219], v[24:27], a[20:23], v[216:219]
    ds_read_b64_tr_b16 a[10:11], v237 offset:38912
    v_mfma_f32_16x16x32_bf16 v[220:223], v[56:59], a[20:23], v[220:223]
    ds_read_b64_tr_b16 a[12:13], v238 offset:36864
    v_mfma_f32_16x16x32_bf16 v[224:227], v[88:91], a[20:23], v[224:227]
    ds_read_b64_tr_b16 a[14:15], v238 offset:38912
    v_mfma_f32_16x16x32_bf16 v[204:207], v[28:31], a[24:27], v[204:207]
    ds_read_b64_tr_b16 a[16:17], v237 offset:40960
    v_mfma_f32_16x16x32_bf16 v[208:211], v[60:63], a[24:27], v[208:211]
    buffer_load_dwordx4 v229, s[24:27], s47 offen offset:1024 lds
    v_mfma_f32_16x16x32_bf16 v[212:215], v[92:95], a[24:27], v[212:215]
    ds_read_b64_tr_b16 a[18:19], v237 offset:43008
    v_mfma_f32_16x16x32_bf16 v[216:219], v[28:31], a[28:31], v[216:219]
    ds_read_b64_tr_b16 a[20:21], v238 offset:40960
    v_mfma_f32_16x16x32_bf16 v[220:223], v[60:63], a[28:31], v[220:223]
    ds_read_b64_tr_b16 a[22:23], v238 offset:43008
    v_mfma_f32_16x16x32_bf16 v[224:227], v[92:95], a[28:31], v[224:227]
    ds_read_b64_tr_b16 a[24:25], v237 offset:45056
    s_waitcnt lgkmcnt(9)
    v_mfma_f32_16x16x32_bf16 v[180:183], v[0:3], a[0:3], 0
    ds_read_b64_tr_b16 a[26:27], v237 offset:47104
    v_mfma_f32_16x16x32_bf16 v[184:187], v[32:35], a[0:3], 0
    buffer_load_dwordx4 v230, s[24:27], s47 offen offset:2048 lds
    v_mfma_f32_16x16x32_bf16 v[188:191], v[64:67], a[0:3], 0
    ds_read_b64_tr_b16 a[28:29], v238 offset:45056
    v_mfma_f32_16x16x32_bf16 v[192:195], v[0:3], a[4:7], 0
    ds_read_b64_tr_b16 a[30:31], v238 offset:47104
    v_mfma_f32_16x16x32_bf16 v[196:199], v[32:35], a[4:7], 0
    ds_read_b64_tr_b16 a[0:1], v237 offset:49152
    v_mfma_f32_16x16x32_bf16 v[200:203], v[64:67], a[4:7], 0
    ds_read_b64_tr_b16 a[2:3], v237 offset:51200
    s_waitcnt lgkmcnt(10)
    v_mfma_f32_16x16x32_bf16 v[180:183], v[4:7], a[8:11], v[180:183]
    ds_read_b64_tr_b16 a[4:5], v238 offset:49152
    v_cvt_pk_bf16_f32 v150, v204, v205
    v_mfma_f32_16x16x32_bf16 v[184:187], v[36:39], a[8:11], v[184:187]
    buffer_load_dwordx4 v231, s[24:27], s47 offen offset:3072 lds
    v_mfma_f32_16x16x32_bf16 v[188:191], v[68:71], a[8:11], v[188:191]
    ds_read_b64_tr_b16 a[6:7], v238 offset:51200
    v_cvt_pk_bf16_f32 v151, v206, v207
    v_mfma_f32_16x16x32_bf16 v[192:195], v[4:7], a[12:15], v[192:195]
    ds_read_b64_tr_b16 a[8:9], v237 offset:53248
    v_cvt_pk_bf16_f32 v152, v208, v209
    v_mfma_f32_16x16x32_bf16 v[196:199], v[36:39], a[12:15], v[196:199]
    ds_read_b64_tr_b16 a[10:11], v237 offset:55296
    v_cvt_pk_bf16_f32 v153, v210, v211
    v_mfma_f32_16x16x32_bf16 v[200:203], v[68:71], a[12:15], v[200:203]
    v_cvt_pk_bf16_f32 v158, v212, v213
    s_waitcnt lgkmcnt(10)
    v_mfma_f32_16x16x32_bf16 v[180:183], v[8:11], a[16:19], v[180:183]
    ds_read_b64_tr_b16 a[12:13], v238 offset:53248
    v_cvt_pk_bf16_f32 v159, v214, v215
    v_mfma_f32_16x16x32_bf16 v[184:187], v[40:43], a[16:19], v[184:187]
    ds_read_b64_tr_b16 a[14:15], v238 offset:55296
    v_cvt_pk_bf16_f32 v154, v216, v217
    v_mfma_f32_16x16x32_bf16 v[188:191], v[72:75], a[16:19], v[188:191]
    v_cvt_pk_bf16_f32 v155, v218, v219
    v_cvt_pk_bf16_f32 v156, v220, v221
    v_mfma_f32_16x16x32_bf16 v[192:195], v[8:11], a[20:23], v[192:195]
    ds_read_b64_tr_b16 a[16:17], v237 offset:57344
    v_cvt_pk_bf16_f32 v157, v222, v223
    v_mfma_f32_16x16x32_bf16 v[196:199], v[40:43], a[20:23], v[196:199]
    ds_read_b64_tr_b16 a[18:19], v237 offset:59392
    v_cvt_pk_bf16_f32 v160, v224, v225
    v_mfma_f32_16x16x32_bf16 v[200:203], v[72:75], a[20:23], v[200:203]
    v_cvt_pk_bf16_f32 v161, v226, v227
    s_waitcnt lgkmcnt(10)
    v_mfma_f32_16x16x32_bf16 v[180:183], v[12:15], a[24:27], v[180:183]
    ds_read_b64_tr_b16 a[20:21], v238 offset:57344
    v_accvgpr_write_b32 a34, v158
    v_mfma_f32_16x16x32_bf16 v[184:187], v[44:47], a[24:27], v[184:187]
    ds_read_b64_tr_b16 a[22:23], v238 offset:59392
    v_accvgpr_write_b32 a35, v159
    v_mfma_f32_16x16x32_bf16 v[188:191], v[76:79], a[24:27], v[188:191]
    v_accvgpr_write_b32 a38, v160
    v_accvgpr_write_b32 a39, v161
    v_mfma_f32_16x16x32_bf16 a[40:43], v[150:153], v[126:129], a[40:43]
    s_add_u32 m0, s50, 4096
    v_mfma_f32_16x16x32_bf16 a[44:47], v[150:153], v[130:133], a[44:47]
    buffer_load_dwordx4 v228, s[24:27], s48 offen offset:0 lds
    v_mfma_f32_16x16x32_bf16 a[48:51], v[150:153], v[134:137], a[48:51]
    v_mfma_f32_16x16x32_bf16 a[52:55], v[154:157], v[126:129], a[52:55]
    v_mfma_f32_16x16x32_bf16 a[56:59], v[154:157], v[130:133], a[56:59]
    v_mfma_f32_16x16x32_bf16 a[60:63], v[154:157], v[134:137], a[60:63]
    v_mfma_f32_16x16x32_bf16 v[192:195], v[12:15], a[28:31], v[192:195]
    buffer_load_dwordx4 v229, s[24:27], s48 offen offset:1024 lds
    v_mfma_f32_16x16x32_bf16 v[196:199], v[44:47], a[28:31], v[196:199]
    ds_read_b64_tr_b16 a[24:25], v237 offset:61440
    v_mfma_f32_16x16x32_bf16 v[200:203], v[76:79], a[28:31], v[200:203]
    ds_read_b64_tr_b16 a[26:27], v237 offset:63488
    s_waitcnt lgkmcnt(10)
    v_mfma_f32_16x16x32_bf16 v[180:183], v[16:19], a[0:3], v[180:183]
    ds_read_b64_tr_b16 a[28:29], v238 offset:61440
    v_mfma_f32_16x16x32_bf16 v[184:187], v[48:51], a[0:3], v[184:187]
    ds_read_b64_tr_b16 a[30:31], v238 offset:63488
    v_mfma_f32_16x16x32_bf16 v[188:191], v[80:83], a[0:3], v[188:191]
    buffer_load_dwordx4 v230, s[24:27], s48 offen offset:2048 lds
    v_mfma_f32_16x16x32_bf16 a[40:43], a[32:35], v[138:141], a[40:43]
    v_mfma_f32_16x16x32_bf16 a[44:47], a[32:35], v[142:145], a[44:47]
    v_mfma_f32_16x16x32_bf16 a[48:51], a[32:35], v[146:149], a[48:51]
    v_mfma_f32_16x16x32_bf16 a[52:55], a[36:39], v[138:141], a[52:55]
    v_mfma_f32_16x16x32_bf16 a[56:59], a[36:39], v[142:145], a[56:59]
    v_mfma_f32_16x16x32_bf16 a[60:63], a[36:39], v[146:149], a[60:63]
    buffer_load_dwordx4 v231, s[24:27], s48 offen offset:3072 lds
    v_mfma_f32_16x16x32_bf16 v[192:195], v[16:19], a[4:7], v[192:195]
    v_mfma_f32_16x16x32_bf16 v[196:199], v[48:51], a[4:7], v[196:199]
    v_mfma_f32_16x16x32_bf16 v[200:203], v[80:83], a[4:7], v[200:203]
    s_waitcnt lgkmcnt(8)
    v_mfma_f32_16x16x32_bf16 v[180:183], v[20:23], a[8:11], v[180:183]
    v_mfma_f32_16x16x32_bf16 v[184:187], v[52:55], a[8:11], v[184:187]
    v_mfma_f32_16x16x32_bf16 v[188:191], v[84:87], a[8:11], v[188:191]
    s_waitcnt vmcnt(8) lgkmcnt(0)
    s_barrier
    v_mfma_f32_16x16x32_bf16 v[192:195], v[20:23], a[12:15], v[192:195]
    ds_read_b64_tr_b16 a[0:1], v239 offset:0
    s_add_u32 s47, s59, 229888
    v_mfma_f32_16x16x32_bf16 v[196:199], v[52:55], a[12:15], v[196:199]
    ds_read_b64_tr_b16 a[2:3], v239 offset:2048
    s_add_u32 s48, s59, 258560
    v_mfma_f32_16x16x32_bf16 v[200:203], v[84:87], a[12:15], v[200:203]
    ds_read_b64_tr_b16 a[4:5], v240 offset:0
    v_mfma_f32_16x16x32_bf16 v[180:183], v[24:27], a[16:19], v[180:183]
    ds_read_b64_tr_b16 a[6:7], v240 offset:2048
    s_add_u32 m0, s50, 32768
    v_mfma_f32_16x16x32_bf16 v[184:187], v[56:59], a[16:19], v[184:187]
    buffer_load_dwordx4 v228, s[24:27], s47 offen offset:0 lds
    v_mfma_f32_16x16x32_bf16 v[188:191], v[88:91], a[16:19], v[188:191]
    ds_read_b64_tr_b16 a[8:9], v239 offset:4096
    s_add_u32 s54, s52, 0
    v_mfma_f32_16x16x32_bf16 v[192:195], v[24:27], a[20:23], v[192:195]
    ds_read_b64_tr_b16 a[10:11], v239 offset:6144
    v_accvgpr_read_b32 v96, a40
    v_mfma_f32_16x16x32_bf16 v[196:199], v[56:59], a[20:23], v[196:199]
    ds_read_b64_tr_b16 a[12:13], v240 offset:4096
    v_accvgpr_read_b32 v97, a41
    v_mfma_f32_16x16x32_bf16 v[200:203], v[88:91], a[20:23], v[200:203]
    ds_read_b64_tr_b16 a[14:15], v240 offset:6144
    v_mfma_f32_16x16x32_bf16 v[180:183], v[28:31], a[24:27], v[180:183]
    buffer_load_dwordx4 v229, s[24:27], s47 offen offset:1024 lds
    v_mfma_f32_16x16x32_bf16 v[184:187], v[60:63], a[24:27], v[184:187]
    ds_read_b64_tr_b16 a[16:17], v239 offset:8192
    v_accvgpr_read_b32 v98, a42
    v_mfma_f32_16x16x32_bf16 v[188:191], v[92:95], a[24:27], v[188:191]
    ds_read_b64_tr_b16 a[18:19], v239 offset:10240
    v_accvgpr_read_b32 v99, a43
    v_mfma_f32_16x16x32_bf16 v[192:195], v[28:31], a[28:31], v[192:195]
    ds_read_b64_tr_b16 a[20:21], v240 offset:8192
    v_accvgpr_read_b32 v100, a52
    v_mfma_f32_16x16x32_bf16 v[196:199], v[60:63], a[28:31], v[196:199]
    ds_read_b64_tr_b16 a[22:23], v240 offset:10240
    v_accvgpr_read_b32 v101, a53
    v_mfma_f32_16x16x32_bf16 v[200:203], v[92:95], a[28:31], v[200:203]
    ds_read_b64_tr_b16 a[24:25], v239 offset:12288
    s_waitcnt lgkmcnt(9)
    v_mfma_f32_16x16x32_bf16 v[204:207], v[0:3], a[0:3], 0
    buffer_load_dwordx4 v230, s[24:27], s47 offen offset:2048 lds
    v_mfma_f32_16x16x32_bf16 v[208:211], v[32:35], a[0:3], 0
    ds_read_b64_tr_b16 a[26:27], v239 offset:14336
    v_accvgpr_read_b32 v102, a54
    v_mfma_f32_16x16x32_bf16 v[212:215], v[64:67], a[0:3], 0
    ds_read_b64_tr_b16 a[28:29], v240 offset:12288
    v_accvgpr_read_b32 v103, a55
    v_mfma_f32_16x16x32_bf16 v[216:219], v[0:3], a[4:7], 0
    ds_read_b64_tr_b16 a[30:31], v240 offset:14336
    v_cvt_pk_bf16_f32 v96, v96, v97
    v_mfma_f32_16x16x32_bf16 v[220:223], v[32:35], a[4:7], 0
    buffer_load_dwordx4 v231, s[24:27], s47 offen offset:3072 lds
    v_mfma_f32_16x16x32_bf16 v[224:227], v[64:67], a[4:7], 0
    ds_read_b64_tr_b16 a[0:1], v239 offset:16384
    s_waitcnt lgkmcnt(9)
    v_mfma_f32_16x16x32_bf16 v[204:207], v[4:7], a[8:11], v[204:207]
    ds_read_b64_tr_b16 a[2:3], v239 offset:18432
    v_cvt_pk_bf16_f32 v150, v180, v181
    v_mfma_f32_16x16x32_bf16 v[208:211], v[36:39], a[8:11], v[208:211]
    ds_read_b64_tr_b16 a[4:5], v240 offset:16384
    v_cvt_pk_bf16_f32 v151, v182, v183
    v_mfma_f32_16x16x32_bf16 v[212:215], v[68:71], a[8:11], v[212:215]
    ds_read_b64_tr_b16 a[6:7], v240 offset:18432
    v_cvt_pk_bf16_f32 v152, v184, v185
    v_mfma_f32_16x16x32_bf16 v[216:219], v[4:7], a[12:15], v[216:219]
    ds_read_b64_tr_b16 a[8:9], v239 offset:20480
    v_cvt_pk_bf16_f32 v153, v186, v187
    v_mfma_f32_16x16x32_bf16 v[220:223], v[36:39], a[12:15], v[220:223]
    ds_read_b64_tr_b16 a[10:11], v239 offset:22528
    v_cvt_pk_bf16_f32 v158, v188, v189
    v_mfma_f32_16x16x32_bf16 v[224:227], v[68:71], a[12:15], v[224:227]
    v_cvt_pk_bf16_f32 v159, v190, v191
    s_waitcnt lgkmcnt(10)
    v_mfma_f32_16x16x32_bf16 v[204:207], v[8:11], a[16:19], v[204:207]
    ds_read_b64_tr_b16 a[12:13], v240 offset:20480
    v_cvt_pk_bf16_f32 v154, v192, v193
    v_mfma_f32_16x16x32_bf16 v[208:211], v[40:43], a[16:19], v[208:211]
    ds_read_b64_tr_b16 a[14:15], v240 offset:22528
    v_cvt_pk_bf16_f32 v155, v194, v195
    v_mfma_f32_16x16x32_bf16 v[212:215], v[72:75], a[16:19], v[212:215]
    v_cvt_pk_bf16_f32 v156, v196, v197
    v_cvt_pk_bf16_f32 v157, v198, v199
    v_mfma_f32_16x16x32_bf16 v[216:219], v[8:11], a[20:23], v[216:219]
    ds_read_b64_tr_b16 a[16:17], v239 offset:24576
    v_cvt_pk_bf16_f32 v160, v200, v201
    v_mfma_f32_16x16x32_bf16 v[220:223], v[40:43], a[20:23], v[220:223]
    ds_read_b64_tr_b16 a[18:19], v239 offset:26624
    v_cvt_pk_bf16_f32 v161, v202, v203
    v_mfma_f32_16x16x32_bf16 v[224:227], v[72:75], a[20:23], v[224:227]
    v_accvgpr_write_b32 a210, v158
    s_waitcnt lgkmcnt(10)
    v_mfma_f32_16x16x32_bf16 v[204:207], v[12:15], a[24:27], v[204:207]
    ds_read_b64_tr_b16 a[20:21], v240 offset:24576
    v_accvgpr_write_b32 a211, v159
    v_mfma_f32_16x16x32_bf16 v[208:211], v[44:47], a[24:27], v[208:211]
    ds_read_b64_tr_b16 a[22:23], v240 offset:26624
    v_accvgpr_write_b32 a214, v160
    v_mfma_f32_16x16x32_bf16 v[212:215], v[76:79], a[24:27], v[212:215]
    v_accvgpr_write_b32 a215, v161
    s_add_u32 m0, s50, 36864
    v_mfma_f32_16x16x32_bf16 a[64:67], v[150:153], v[126:129], a[64:67]
    buffer_load_dwordx4 v228, s[24:27], s48 offen offset:0 lds
    v_mfma_f32_16x16x32_bf16 a[68:71], v[150:153], v[130:133], a[68:71]
    v_cvt_pk_bf16_f32 v97, v98, v99
    v_cvt_pk_bf16_f32 v98, v100, v101
    v_mfma_f32_16x16x32_bf16 a[72:75], v[150:153], v[134:137], a[72:75]
    v_cvt_pk_bf16_f32 v99, v102, v103
    v_accvgpr_read_b32 v104, a44
    v_mfma_f32_16x16x32_bf16 a[76:79], v[154:157], v[126:129], a[76:79]
    buffer_load_dwordx4 v229, s[24:27], s48 offen offset:1024 lds
    v_mfma_f32_16x16x32_bf16 a[80:83], v[154:157], v[130:133], a[80:83]
    v_accvgpr_read_b32 v105, a45
    v_accvgpr_read_b32 v106, a46
    v_mfma_f32_16x16x32_bf16 a[84:87], v[154:157], v[134:137], a[84:87]
    v_accvgpr_read_b32 v107, a47
    v_accvgpr_read_b32 v108, a56
    v_mfma_f32_16x16x32_bf16 v[216:219], v[12:15], a[28:31], v[216:219]
    buffer_load_dwordx4 v230, s[24:27], s48 offen offset:2048 lds
    v_mfma_f32_16x16x32_bf16 v[220:223], v[44:47], a[28:31], v[220:223]
    ds_read_b64_tr_b16 a[24:25], v239 offset:28672
    v_accvgpr_read_b32 v109, a57
    v_mfma_f32_16x16x32_bf16 v[224:227], v[76:79], a[28:31], v[224:227]
    ds_read_b64_tr_b16 a[26:27], v239 offset:30720
    s_waitcnt lgkmcnt(10)
    v_mfma_f32_16x16x32_bf16 v[204:207], v[16:19], a[0:3], v[204:207]
    buffer_load_dwordx4 v231, s[24:27], s48 offen offset:3072 lds
    v_mfma_f32_16x16x32_bf16 v[208:211], v[48:51], a[0:3], v[208:211]
    ds_read_b64_tr_b16 a[28:29], v240 offset:28672
    v_accvgpr_read_b32 v110, a58
    v_mfma_f32_16x16x32_bf16 v[212:215], v[80:83], a[0:3], v[212:215]
    ds_read_b64_tr_b16 a[30:31], v240 offset:30720
    v_accvgpr_read_b32 v111, a59
    v_mfma_f32_16x16x32_bf16 a[64:67], a[208:211], v[138:141], a[64:67]
    buffer_store_dwordx4 v[96:99], v241, s[28:31], s54 offen offset:0 sc1
    v_mfma_f32_16x16x32_bf16 a[68:71], a[208:211], v[142:145], a[68:71]
    v_cvt_pk_bf16_f32 v104, v104, v105
    v_cvt_pk_bf16_f32 v105, v106, v107
    v_mfma_f32_16x16x32_bf16 a[72:75], a[208:211], v[146:149], a[72:75]
    v_cvt_pk_bf16_f32 v106, v108, v109
    v_cvt_pk_bf16_f32 v107, v110, v111
    v_mfma_f32_16x16x32_bf16 a[76:79], a[212:215], v[138:141], a[76:79]
    buffer_store_dwordx4 v[104:107], v241, s[28:31], s54 offen offset:1024 sc1
    v_mfma_f32_16x16x32_bf16 a[80:83], a[212:215], v[142:145], a[80:83]
    v_accvgpr_read_b32 v112, a48
    v_accvgpr_read_b32 v113, a49
    v_mfma_f32_16x16x32_bf16 a[84:87], a[212:215], v[146:149], a[84:87]
    v_accvgpr_read_b32 v114, a50
    v_accvgpr_read_b32 v115, a51
    v_mfma_f32_16x16x32_bf16 v[216:219], v[16:19], a[4:7], v[216:219]
    v_accvgpr_read_b32 v116, a60
    v_accvgpr_read_b32 v117, a61
    v_mfma_f32_16x16x32_bf16 v[220:223], v[48:51], a[4:7], v[220:223]
    v_accvgpr_read_b32 v118, a62
    v_accvgpr_read_b32 v119, a63
    v_mfma_f32_16x16x32_bf16 v[224:227], v[80:83], a[4:7], v[224:227]
    v_cvt_pk_bf16_f32 v112, v112, v113
    s_waitcnt lgkmcnt(8)
    v_mfma_f32_16x16x32_bf16 v[204:207], v[20:23], a[8:11], v[204:207]
    v_cvt_pk_bf16_f32 v113, v114, v115
    v_cvt_pk_bf16_f32 v114, v116, v117
    v_mfma_f32_16x16x32_bf16 v[208:211], v[52:55], a[8:11], v[208:211]
    v_cvt_pk_bf16_f32 v115, v118, v119
    v_mfma_f32_16x16x32_bf16 v[212:215], v[84:87], a[8:11], v[212:215]
    buffer_store_dwordx4 v[112:115], v241, s[28:31], s54 offen offset:2048 sc1
    s_waitcnt vmcnt(11) lgkmcnt(0)
    s_barrier
    s_cmp_lg_u32 s32, 0
    s_cbranch_scc1 L_wl_0
    s_mov_b64 exec, 1
    buffer_load_dword v245, v253, s[4:7], s95 offen offset:0 sc1
    s_mov_b64 exec, -1
L_wl_0:
    v_mfma_f32_16x16x32_bf16 v[216:219], v[20:23], a[12:15], v[216:219]
    ds_read_b64_tr_b16 a[0:1], v237 offset:0
    s_add_u32 s47, s59, 230016
    v_mfma_f32_16x16x32_bf16 v[220:223], v[52:55], a[12:15], v[220:223]
    ds_read_b64_tr_b16 a[2:3], v237 offset:2048
    s_add_u32 s48, s59, 258688
    v_mfma_f32_16x16x32_bf16 v[224:227], v[84:87], a[12:15], v[224:227]
    ds_read_b64_tr_b16 a[4:5], v238 offset:0
    v_mfma_f32_16x16x32_bf16 v[204:207], v[24:27], a[16:19], v[204:207]
    ds_read_b64_tr_b16 a[6:7], v238 offset:2048
    s_add_u32 m0, s50, 65536
    v_mfma_f32_16x16x32_bf16 v[208:211], v[56:59], a[16:19], v[208:211]
    buffer_load_dwordx4 v228, s[24:27], s47 offen offset:0 lds
    v_mfma_f32_16x16x32_bf16 v[212:215], v[88:91], a[16:19], v[212:215]
    ds_read_b64_tr_b16 a[8:9], v237 offset:4096
    s_add_u32 s54, s52, 6144
    v_mfma_f32_16x16x32_bf16 v[216:219], v[24:27], a[20:23], v[216:219]
    ds_read_b64_tr_b16 a[10:11], v237 offset:6144
    v_accvgpr_read_b32 v96, a64
    v_mfma_f32_16x16x32_bf16 v[220:223], v[56:59], a[20:23], v[220:223]
    ds_read_b64_tr_b16 a[12:13], v238 offset:4096
    v_accvgpr_read_b32 v97, a65
    v_mfma_f32_16x16x32_bf16 v[224:227], v[88:91], a[20:23], v[224:227]
    ds_read_b64_tr_b16 a[14:15], v238 offset:6144
    v_mfma_f32_16x16x32_bf16 v[204:207], v[28:31], a[24:27], v[204:207]
    buffer_load_dwordx4 v229, s[24:27], s47 offen offset:1024 lds
    v_mfma_f32_16x16x32_bf16 v[208:211], v[60:63], a[24:27], v[208:211]
    ds_read_b64_tr_b16 a[16:17], v237 offset:8192
    v_accvgpr_read_b32 v98, a66
    v_mfma_f32_16x16x32_bf16 v[212:215], v[92:95], a[24:27], v[212:215]
    ds_read_b64_tr_b16 a[18:19], v237 offset:10240
    v_accvgpr_read_b32 v99, a67
    v_mfma_f32_16x16x32_bf16 v[216:219], v[28:31], a[28:31], v[216:219]
    ds_read_b64_tr_b16 a[20:21], v238 offset:8192
    v_accvgpr_read_b32 v100, a76
    v_mfma_f32_16x16x32_bf16 v[220:223], v[60:63], a[28:31], v[220:223]
    ds_read_b64_tr_b16 a[22:23], v238 offset:10240
    v_accvgpr_read_b32 v101, a77
    v_mfma_f32_16x16x32_bf16 v[224:227], v[92:95], a[28:31], v[224:227]
    ds_read_b64_tr_b16 a[24:25], v237 offset:12288
    s_waitcnt lgkmcnt(9)
    v_mfma_f32_16x16x32_bf16 v[180:183], v[0:3], a[0:3], 0
    buffer_load_dwordx4 v230, s[24:27], s47 offen offset:2048 lds
    v_mfma_f32_16x16x32_bf16 v[184:187], v[32:35], a[0:3], 0
    ds_read_b64_tr_b16 a[26:27], v237 offset:14336
    v_accvgpr_read_b32 v102, a78
    v_mfma_f32_16x16x32_bf16 v[188:191], v[64:67], a[0:3], 0
    ds_read_b64_tr_b16 a[28:29], v238 offset:12288
    v_accvgpr_read_b32 v103, a79
    v_mfma_f32_16x16x32_bf16 v[192:195], v[0:3], a[4:7], 0
    ds_read_b64_tr_b16 a[30:31], v238 offset:14336
    v_cvt_pk_bf16_f32 v96, v96, v97
    v_mfma_f32_16x16x32_bf16 v[196:199], v[32:35], a[4:7], 0
    buffer_load_dwordx4 v231, s[24:27], s47 offen offset:3072 lds
    v_mfma_f32_16x16x32_bf16 v[200:203], v[64:67], a[4:7], 0
    ds_read_b64_tr_b16 a[0:1], v237 offset:16384
    s_waitcnt lgkmcnt(9)
    v_mfma_f32_16x16x32_bf16 v[180:183], v[4:7], a[8:11], v[180:183]
    ds_read_b64_tr_b16 a[2:3], v237 offset:18432
    v_cvt_pk_bf16_f32 v150, v204, v205
    v_mfma_f32_16x16x32_bf16 v[184:187], v[36:39], a[8:11], v[184:187]
    ds_read_b64_tr_b16 a[4:5], v238 offset:16384
    v_cvt_pk_bf16_f32 v151, v206, v207
    v_mfma_f32_16x16x32_bf16 v[188:191], v[68:71], a[8:11], v[188:191]
    ds_read_b64_tr_b16 a[6:7], v238 offset:18432
    v_cvt_pk_bf16_f32 v152, v208, v209
    v_mfma_f32_16x16x32_bf16 v[192:195], v[4:7], a[12:15], v[192:195]
    ds_read_b64_tr_b16 a[8:9], v237 offset:20480
    v_cvt_pk_bf16_f32 v153, v210, v211
    v_mfma_f32_16x16x32_bf16 v[196:199], v[36:39], a[12:15], v[196:199]
    ds_read_b64_tr_b16 a[10:11], v237 offset:22528
    v_cvt_pk_bf16_f32 v158, v212, v213
    v_mfma_f32_16x16x32_bf16 v[200:203], v[68:71], a[12:15], v[200:203]
    v_cvt_pk_bf16_f32 v159, v214, v215
    s_waitcnt lgkmcnt(10)
    v_mfma_f32_16x16x32_bf16 v[180:183], v[8:11], a[16:19], v[180:183]
    ds_read_b64_tr_b16 a[12:13], v238 offset:20480
    v_cvt_pk_bf16_f32 v154, v216, v217
    v_mfma_f32_16x16x32_bf16 v[184:187], v[40:43], a[16:19], v[184:187]
    ds_read_b64_tr_b16 a[14:15], v238 offset:22528
    v_cvt_pk_bf16_f32 v155, v218, v219
    v_mfma_f32_16x16x32_bf16 v[188:191], v[72:75], a[16:19], v[188:191]
    v_cvt_pk_bf16_f32 v156, v220, v221
    v_cvt_pk_bf16_f32 v157, v222, v223
    v_mfma_f32_16x16x32_bf16 v[192:195], v[8:11], a[20:23], v[192:195]
    ds_read_b64_tr_b16 a[16:17], v237 offset:24576
    v_cvt_pk_bf16_f32 v160, v224, v225
    v_mfma_f32_16x16x32_bf16 v[196:199], v[40:43], a[20:23], v[196:199]
    ds_read_b64_tr_b16 a[18:19], v237 offset:26624
    v_cvt_pk_bf16_f32 v161, v226, v227
    v_mfma_f32_16x16x32_bf16 v[200:203], v[72:75], a[20:23], v[200:203]
    v_accvgpr_write_b32 a218, v158
    s_waitcnt lgkmcnt(10)
    v_mfma_f32_16x16x32_bf16 v[180:183], v[12:15], a[24:27], v[180:183]
    ds_read_b64_tr_b16 a[20:21], v238 offset:24576
    v_accvgpr_write_b32 a219, v159
    v_mfma_f32_16x16x32_bf16 v[184:187], v[44:47], a[24:27], v[184:187]
    ds_read_b64_tr_b16 a[22:23], v238 offset:26624
    v_accvgpr_write_b32 a222, v160
    v_mfma_f32_16x16x32_bf16 v[188:191], v[76:79], a[24:27], v[188:191]
    v_accvgpr_write_b32 a223, v161
    s_add_u32 m0, s50, 69632
    v_mfma_f32_16x16x32_bf16 a[88:91], v[150:153], v[126:129], a[88:91]
    buffer_load_dwordx4 v228, s[24:27], s48 offen offset:0 lds
    v_mfma_f32_16x16x32_bf16 a[92:95], v[150:153], v[130:133], a[92:95]
    v_cvt_pk_bf16_f32 v97, v98, v99
    v_cvt_pk_bf16_f32 v98, v100, v101
    v_mfma_f32_16x16x32_bf16 a[96:99], v[150:153], v[134:137], a[96:99]
    v_cvt_pk_bf16_f32 v99, v102, v103
    v_accvgpr_read_b32 v104, a68
    v_mfma_f32_16x16x32_bf16 a[100:103], v[154:157], v[126:129], a[100:103]
    buffer_load_dwordx4 v229, s[24:27], s48 offen offset:1024 lds
    v_mfma_f32_16x16x32_bf16 a[104:107], v[154:157], v[130:133], a[104:107]
    v_accvgpr_read_b32 v105, a69
    v_accvgpr_read_b32 v106, a70
    v_mfma_f32_16x16x32_bf16 a[108:111], v[154:157], v[134:137], a[108:111]
    v_accvgpr_read_b32 v107, a71
    v_accvgpr_read_b32 v108, a80
    v_mfma_f32_16x16x32_bf16 v[192:195], v[12:15], a[28:31], v[192:195]
    buffer_load_dwordx4 v230, s[24:27], s48 offen offset:2048 lds
    v_mfma_f32_16x16x32_bf16 v[196:199], v[44:47], a[28:31], v[196:199]
    ds_read_b64_tr_b16 a[24:25], v237 offset:28672
    v_accvgpr_read_b32 v109, a81
    v_mfma_f32_16x16x32_bf16 v[200:203], v[76:79], a[28:31], v[200:203]
    ds_read_b64_tr_b16 a[26:27], v237 offset:30720
    s_waitcnt lgkmcnt(10)
    v_mfma_f32_16x16x32_bf16 v[180:183], v[16:19], a[0:3], v[180:183]
    buffer_load_dwordx4 v231, s[24:27], s48 offen offset:3072 lds
    v_mfma_f32_16x16x32_bf16 v[184:187], v[48:51], a[0:3], v[184:187]
    ds_read_b64_tr_b16 a[28:29], v238 offset:28672
    v_accvgpr_read_b32 v110, a82
    v_mfma_f32_16x16x32_bf16 v[188:191], v[80:83], a[0:3], v[188:191]
    ds_read_b64_tr_b16 a[30:31], v238 offset:30720
    v_accvgpr_read_b32 v111, a83
    v_mfma_f32_16x16x32_bf16 a[88:91], a[216:219], v[138:141], a[88:91]
    buffer_store_dwordx4 v[96:99], v241, s[28:31], s54 offen offset:0 sc1
    v_mfma_f32_16x16x32_bf16 a[92:95], a[216:219], v[142:145], a[92:95]
    v_cvt_pk_bf16_f32 v104, v104, v105
    v_cvt_pk_bf16_f32 v105, v106, v107
    v_mfma_f32_16x16x32_bf16 a[96:99], a[216:219], v[146:149], a[96:99]
    v_cvt_pk_bf16_f32 v106, v108, v109
    v_cvt_pk_bf16_f32 v107, v110, v111
    v_mfma_f32_16x16x32_bf16 a[100:103], a[220:223], v[138:141], a[100:103]
    buffer_store_dwordx4 v[104:107], v241, s[28:31], s54 offen offset:1024 sc1
    v_mfma_f32_16x16x32_bf16 a[104:107], a[220:223], v[142:145], a[104:107]
    v_accvgpr_read_b32 v112, a72
    v_accvgpr_read_b32 v113, a73
    v_mfma_f32_16x16x32_bf16 a[108:111], a[220:223], v[146:149], a[108:111]
    v_accvgpr_read_b32 v114, a74
    v_accvgpr_read_b32 v115, a75
    v_mfma_f32_16x16x32_bf16 v[192:195], v[16:19], a[4:7], v[192:195]
    v_accvgpr_read_b32 v116, a84
    v_accvgpr_read_b32 v117, a85
    v_mfma_f32_16x16x32_bf16 v[196:199], v[48:51], a[4:7], v[196:199]
    v_accvgpr_read_b32 v118, a86
    v_accvgpr_read_b32 v119, a87
    v_mfma_f32_16x16x32_bf16 v[200:203], v[80:83], a[4:7], v[200:203]
    v_cvt_pk_bf16_f32 v112, v112, v113
    s_waitcnt lgkmcnt(8)
    v_mfma_f32_16x16x32_bf16 v[180:183], v[20:23], a[8:11], v[180:183]
    v_cvt_pk_bf16_f32 v113, v114, v115
    v_cvt_pk_bf16_f32 v114, v116, v117
    v_mfma_f32_16x16x32_bf16 v[184:187], v[52:55], a[8:11], v[184:187]
    v_cvt_pk_bf16_f32 v115, v118, v119
    v_mfma_f32_16x16x32_bf16 v[188:191], v[84:87], a[8:11], v[188:191]
    buffer_store_dwordx4 v[112:115], v241, s[28:31], s54 offen offset:2048 sc1
    s_waitcnt vmcnt(14) lgkmcnt(0)
    s_barrier
    v_mfma_f32_16x16x32_bf16 v[192:195], v[20:23], a[12:15], v[192:195]
    ds_read_b64_tr_b16 a[0:1], v237 offset:32768
    s_add_u32 s47, s59, 230144
    v_mfma_f32_16x16x32_bf16 v[196:199], v[52:55], a[12:15], v[196:199]
    ds_read_b64_tr_b16 a[2:3], v237 offset:34816
    s_add_u32 s48, s59, 258816
    v_mfma_f32_16x16x32_bf16 v[200:203], v[84:87], a[12:15], v[200:203]
    ds_read_b64_tr_b16 a[4:5], v238 offset:32768
    v_mfma_f32_16x16x32_bf16 v[180:183], v[24:27], a[16:19], v[180:183]
    ds_read_b64_tr_b16 a[6:7], v238 offset:34816
    s_add_u32 m0, s50, 0
    v_mfma_f32_16x16x32_bf16 v[184:187], v[56:59], a[16:19], v[184:187]
    buffer_load_dwordx4 v228, s[24:27], s47 offen offset:0 lds
    v_mfma_f32_16x16x32_bf16 v[188:191], v[88:91], a[16:19], v[188:191]
    ds_read_b64_tr_b16 a[8:9], v237 offset:36864
    s_add_u32 s54, s52, 12288
    v_mfma_f32_16x16x32_bf16 v[192:195], v[24:27], a[20:23], v[192:195]
    ds_read_b64_tr_b16 a[10:11], v237 offset:38912
    v_accvgpr_read_b32 v96, a88
    v_mfma_f32_16x16x32_bf16 v[196:199], v[56:59], a[20:23], v[196:199]
    ds_read_b64_tr_b16 a[12:13], v238 offset:36864
    v_accvgpr_read_b32 v97, a89
    v_mfma_f32_16x16x32_bf16 v[200:203], v[88:91], a[20:23], v[200:203]
    ds_read_b64_tr_b16 a[14:15], v238 offset:38912
    v_mfma_f32_16x16x32_bf16 v[180:183], v[28:31], a[24:27], v[180:183]
    buffer_load_dwordx4 v229, s[24:27], s47 offen offset:1024 lds
    v_mfma_f32_16x16x32_bf16 v[184:187], v[60:63], a[24:27], v[184:187]
    ds_read_b64_tr_b16 a[16:17], v237 offset:40960
    v_accvgpr_read_b32 v98, a90
    v_mfma_f32_16x16x32_bf16 v[188:191], v[92:95], a[24:27], v[188:191]
    ds_read_b64_tr_b16 a[18:19], v237 offset:43008
    v_accvgpr_read_b32 v99, a91
    v_mfma_f32_16x16x32_bf16 v[192:195], v[28:31], a[28:31], v[192:195]
    ds_read_b64_tr_b16 a[20:21], v238 offset:40960
    v_accvgpr_read_b32 v100, a100
    v_mfma_f32_16x16x32_bf16 v[196:199], v[60:63], a[28:31], v[196:199]
    ds_read_b64_tr_b16 a[22:23], v238 offset:43008
    v_accvgpr_read_b32 v101, a101
    v_mfma_f32_16x16x32_bf16 v[200:203], v[92:95], a[28:31], v[200:203]
    ds_read_b64_tr_b16 a[24:25], v237 offset:45056
    s_waitcnt lgkmcnt(9)
    v_mfma_f32_16x16x32_bf16 v[204:207], v[0:3], a[0:3], 0
    buffer_load_dwordx4 v230, s[24:27], s47 offen offset:2048 lds
    v_mfma_f32_16x16x32_bf16 v[208:211], v[32:35], a[0:3], 0
    ds_read_b64_tr_b16 a[26:27], v237 offset:47104
    v_accvgpr_read_b32 v102, a102
    v_mfma_f32_16x16x32_bf16 v[212:215], v[64:67], a[0:3], 0
    ds_read_b64_tr_b16 a[28:29], v238 offset:45056
    v_accvgpr_read_b32 v103, a103
    v_mfma_f32_16x16x32_bf16 v[216:219], v[0:3], a[4:7], 0
    ds_read_b64_tr_b16 a[30:31], v238 offset:47104
    v_cvt_pk_bf16_f32 v96, v96, v97
    v_mfma_f32_16x16x32_bf16 v[220:223], v[32:35], a[4:7], 0
    buffer_load_dwordx4 v231, s[24:27], s47 offen offset:3072 lds
    v_mfma_f32_16x16x32_bf16 v[224:227], v[64:67], a[4:7], 0
    ds_read_b64_tr_b16 a[0:1], v237 offset:49152
    s_waitcnt lgkmcnt(9)
    v_mfma_f32_16x16x32_bf16 v[204:207], v[4:7], a[8:11], v[204:207]
    ds_read_b64_tr_b16 a[2:3], v237 offset:51200
    v_cvt_pk_bf16_f32 v150, v180, v181
    v_mfma_f32_16x16x32_bf16 v[208:211], v[36:39], a[8:11], v[208:211]
    ds_read_b64_tr_b16 a[4:5], v238 offset:49152
    v_cvt_pk_bf16_f32 v151, v182, v183
    v_mfma_f32_16x16x32_bf16 v[212:215], v[68:71], a[8:11], v[212:215]
    ds_read_b64_tr_b16 a[6:7], v238 offset:51200
    v_cvt_pk_bf16_f32 v152, v184, v185
    v_mfma_f32_16x16x32_bf16 v[216:219], v[4:7], a[12:15], v[216:219]
    ds_read_b64_tr_b16 a[8:9], v237 offset:53248
    v_cvt_pk_bf16_f32 v153, v186, v187
    v_mfma_f32_16x16x32_bf16 v[220:223], v[36:39], a[12:15], v[220:223]
    ds_read_b64_tr_b16 a[10:11], v237 offset:55296
    v_cvt_pk_bf16_f32 v158, v188, v189
    v_mfma_f32_16x16x32_bf16 v[224:227], v[68:71], a[12:15], v[224:227]
    v_cvt_pk_bf16_f32 v159, v190, v191
    s_waitcnt lgkmcnt(10)
    v_mfma_f32_16x16x32_bf16 v[204:207], v[8:11], a[16:19], v[204:207]
    ds_read_b64_tr_b16 a[12:13], v238 offset:53248
    v_cvt_pk_bf16_f32 v154, v192, v193
    v_mfma_f32_16x16x32_bf16 v[208:211], v[40:43], a[16:19], v[208:211]
    ds_read_b64_tr_b16 a[14:15], v238 offset:55296
    v_cvt_pk_bf16_f32 v155, v194, v195
    v_mfma_f32_16x16x32_bf16 v[212:215], v[72:75], a[16:19], v[212:215]
    v_cvt_pk_bf16_f32 v156, v196, v197
    v_cvt_pk_bf16_f32 v157, v198, v199
    v_mfma_f32_16x16x32_bf16 v[216:219], v[8:11], a[20:23], v[216:219]
    ds_read_b64_tr_b16 a[16:17], v237 offset:57344
    v_cvt_pk_bf16_f32 v160, v200, v201
    v_mfma_f32_16x16x32_bf16 v[220:223], v[40:43], a[20:23], v[220:223]
    ds_read_b64_tr_b16 a[18:19], v237 offset:59392
    v_cvt_pk_bf16_f32 v161, v202, v203
    v_mfma_f32_16x16x32_bf16 v[224:227], v[72:75], a[20:23], v[224:227]
    v_accvgpr_write_b32 a226, v158
    s_waitcnt lgkmcnt(10)
    v_mfma_f32_16x16x32_bf16 v[204:207], v[12:15], a[24:27], v[204:207]
    ds_read_b64_tr_b16 a[20:21], v238 offset:57344
    v_accvgpr_write_b32 a227, v159
    v_mfma_f32_16x16x32_bf16 v[208:211], v[44:47], a[24:27], v[208:211]
    ds_read_b64_tr_b16 a[22:23], v238 offset:59392
    v_accvgpr_write_b32 a230, v160
    v_mfma_f32_16x16x32_bf16 v[212:215], v[76:79], a[24:27], v[212:215]
    v_accvgpr_write_b32 a231, v161
    s_add_u32 m0, s50, 4096
    v_mfma_f32_16x16x32_bf16 a[112:115], v[150:153], v[126:129], a[112:115]
    buffer_load_dwordx4 v228, s[24:27], s48 offen offset:0 lds
    v_mfma_f32_16x16x32_bf16 a[116:119], v[150:153], v[130:133], a[116:119]
    v_cvt_pk_bf16_f32 v97, v98, v99
    v_cvt_pk_bf16_f32 v98, v100, v101
    v_mfma_f32_16x16x32_bf16 a[120:123], v[150:153], v[134:137], a[120:123]
    v_cvt_pk_bf16_f32 v99, v102, v103
    v_accvgpr_read_b32 v104, a92
    v_mfma_f32_16x16x32_bf16 a[124:127], v[154:157], v[126:129], a[124:127]
    buffer_load_dwordx4 v229, s[24:27], s48 offen offset:1024 lds
    v_mfma_f32_16x16x32_bf16 a[128:131], v[154:157], v[130:133], a[128:131]
    v_accvgpr_read_b32 v105, a93
    v_accvgpr_read_b32 v106, a94
    v_mfma_f32_16x16x32_bf16 a[132:135], v[154:157], v[134:137], a[132:135]
    v_accvgpr_read_b32 v107, a95
    v_accvgpr_read_b32 v108, a104
    v_mfma_f32_16x16x32_bf16 v[216:219], v[12:15], a[28:31], v[216:219]
    buffer_load_dwordx4 v230, s[24:27], s48 offen offset:2048 lds
    v_mfma_f32_16x16x32_bf16 v[220:223], v[44:47], a[28:31], v[220:223]
    ds_read_b64_tr_b16 a[24:25], v237 offset:61440
    v_accvgpr_read_b32 v109, a105
    v_mfma_f32_16x16x32_bf16 v[224:227], v[76:79], a[28:31], v[224:227]
    ds_read_b64_tr_b16 a[26:27], v237 offset:63488
    s_waitcnt lgkmcnt(10)
    v_mfma_f32_16x16x32_bf16 v[204:207], v[16:19], a[0:3], v[204:207]
    buffer_load_dwordx4 v231, s[24:27], s48 offen offset:3072 lds
    v_mfma_f32_16x16x32_bf16 v[208:211], v[48:51], a[0:3], v[208:211]
    ds_read_b64_tr_b16 a[28:29], v238 offset:61440
    v_accvgpr_read_b32 v110, a106
    v_mfma_f32_16x16x32_bf16 v[212:215], v[80:83], a[0:3], v[212:215]
    ds_read_b64_tr_b16 a[30:31], v238 offset:63488
    v_accvgpr_read_b32 v111, a107
    v_mfma_f32_16x16x32_bf16 a[112:115], a[224:227], v[138:141], a[112:115]
    buffer_store_dwordx4 v[96:99], v241, s[28:31], s54 offen offset:0 sc1
    v_mfma_f32_16x16x32_bf16 a[116:119], a[224:227], v[142:145], a[116:119]
    v_cvt_pk_bf16_f32 v104, v104, v105
    v_cvt_pk_bf16_f32 v105, v106, v107
    v_mfma_f32_16x16x32_bf16 a[120:123], a[224:227], v[146:149], a[120:123]
    v_cvt_pk_bf16_f32 v106, v108, v109
    v_cvt_pk_bf16_f32 v107, v110, v111
    v_mfma_f32_16x16x32_bf16 a[124:127], a[228:231], v[138:141], a[124:127]
    buffer_store_dwordx4 v[104:107], v241, s[28:31], s54 offen offset:1024 sc1
    v_mfma_f32_16x16x32_bf16 a[128:131], a[228:231], v[142:145], a[128:131]
    v_accvgpr_read_b32 v112, a96
    v_accvgpr_read_b32 v113, a97
    v_mfma_f32_16x16x32_bf16 a[132:135], a[228:231], v[146:149], a[132:135]
    v_accvgpr_read_b32 v114, a98
    v_accvgpr_read_b32 v115, a99
    v_mfma_f32_16x16x32_bf16 v[216:219], v[16:19], a[4:7], v[216:219]
    v_accvgpr_read_b32 v116, a108
    v_accvgpr_read_b32 v117, a109
    v_mfma_f32_16x16x32_bf16 v[220:223], v[48:51], a[4:7], v[220:223]
    v_accvgpr_read_b32 v118, a110
    v_accvgpr_read_b32 v119, a111
    v_mfma_f32_16x16x32_bf16 v[224:227], v[80:83], a[4:7], v[224:227]
    v_cvt_pk_bf16_f32 v112, v112, v113
    s_waitcnt lgkmcnt(8)
    v_mfma_f32_16x16x32_bf16 v[204:207], v[20:23], a[8:11], v[204:207]
    v_cvt_pk_bf16_f32 v113, v114, v115
    v_cvt_pk_bf16_f32 v114, v116, v117
    v_mfma_f32_16x16x32_bf16 v[208:211], v[52:55], a[8:11], v[208:211]
    v_cvt_pk_bf16_f32 v115, v118, v119
    v_mfma_f32_16x16x32_bf16 v[212:215], v[84:87], a[8:11], v[212:215]
    buffer_store_dwordx4 v[112:115], v241, s[28:31], s54 offen offset:2048 sc1
    s_cmp_lg_u32 s32, 0
    s_cbranch_scc1 L_wf_0
    s_mov_b64 exec, 1
    s_mov_b32 s85, 0x40000
    v_readfirstlane_b32 s87, v252
    s_waitcnt vmcnt(22)
    v_readfirstlane_b32 s86, v245
    s_nop 3
    s_cmp_lg_u32 s86, s87
    s_cbranch_scc1 L_got0_0
L_poll0_0:
    buffer_load_dword v245, v253, s[4:7], s95 offen offset:0 sc1
    s_waitcnt vmcnt(0)
    v_readfirstlane_b32 s86, v245
    s_nop 3
    s_cmp_lg_u32 s86, s87
    s_cbranch_scc1 L_got0_0
    s_sleep 2
    s_sub_u32 s85, s85, 1
    s_cmp_lg_u32 s85, 0
    s_cbranch_scc1 L_poll0_0
L_got0_0:
    s_mov_b64 exec, -1
L_wf_0:
    s_waitcnt vmcnt(11) lgkmcnt(0)
    s_barrier
    s_cmp_lg_u32 s32, 0
    s_cbranch_scc1 L_we_0
    s_mov_b64 exec, 1
    v_mov_b32 v254, 65536
    buffer_atomic_add v254, v253, s[4:7], s95 offen offset:4
    s_mov_b64 exec, -1
L_we_0:
    v_mfma_f32_16x16x32_bf16 v[216:219], v[20:23], a[12:15], v[216:219]
    ds_read_b64_tr_b16 a[0:1], v239 offset:0
    v_mfma_f32_16x16x32_bf16 v[220:223], v[52:55], a[12:15], v[220:223]
    ds_read_b64_tr_b16 a[2:3], v239 offset:2048
    v_mfma_f32_16x16x32_bf16 v[224:227], v[84:87], a[12:15], v[224:227]
    ds_read_b64_tr_b16 a[4:5], v240 offset:0
    v_mfma_f32_16x16x32_bf16 v[204:207], v[24:27], a[16:19], v[204:207]
    ds_read_b64_tr_b16 a[6:7], v240 offset:2048
    s_add_u32 s54, s52, 18432
    v_mfma_f32_16x16x32_bf16 v[208:211], v[56:59], a[16:19], v[208:211]
    ds_read_b64_tr_b16 a[8:9], v239 offset:4096
    v_accvgpr_read_b32 v96, a112
    v_mfma_f32_16x16x32_bf16 v[212:215], v[88:91], a[16:19], v[212:215]
    ds_read_b64_tr_b16 a[10:11], v239 offset:6144
    v_accvgpr_read_b32 v97, a113
    v_mfma_f32_16x16x32_bf16 v[216:219], v[24:27], a[20:23], v[216:219]
    ds_read_b64_tr_b16 a[12:13], v240 offset:4096
    v_accvgpr_read_b32 v98, a114
    v_mfma_f32_16x16x32_bf16 v[220:223], v[56:59], a[20:23], v[220:223]
    ds_read_b64_tr_b16 a[14:15], v240 offset:6144
    v_accvgpr_read_b32 v99, a115
    v_mfma_f32_16x16x32_bf16 v[224:227], v[88:91], a[20:23], v[224:227]
    ds_read_b64_tr_b16 a[16:17], v239 offset:8192
    v_mfma_f32_16x16x32_bf16 v[204:207], v[28:31], a[24:27], v[204:207]
    ds_read_b64_tr_b16 a[18:19], v239 offset:10240
    v_accvgpr_read_b32 v100, a124
    v_mfma_f32_16x16x32_bf16 v[208:211], v[60:63], a[24:27], v[208:211]
    ds_read_b64_tr_b16 a[20:21], v240 offset:8192
    v_accvgpr_read_b32 v101, a125
    v_mfma_f32_16x16x32_bf16 v[212:215], v[92:95], a[24:27], v[212:215]
    ds_read_b64_tr_b16 a[22:23], v240 offset:10240
    v_accvgpr_read_b32 v102, a126
    v_mfma_f32_16x16x32_bf16 v[216:219], v[28:31], a[28:31], v[216:219]
    ds_read_b64_tr_b16 a[24:25], v239 offset:12288
    v_accvgpr_read_b32 v103, a127
    v_mfma_f32_16x16x32_bf16 v[220:223], v[60:63], a[28:31], v[220:223]
    ds_read_b64_tr_b16 a[26:27], v239 offset:14336
    v_cvt_pk_bf16_f32 v96, v96, v97
    v_mfma_f32_16x16x32_bf16 v[224:227], v[92:95], a[28:31], v[224:227]
    v_cvt_pk_bf16_f32 v97, v98, v99
    s_waitcnt lgkmcnt(10)
    v_mfma_f32_16x16x32_bf16 v[180:183], v[0:3], a[0:3], 0
    ds_read_b64_tr_b16 a[28:29], v240 offset:12288
    v_cvt_pk_bf16_f32 v98, v100, v101
    v_mfma_f32_16x16x32_bf16 v[184:187], v[32:35], a[0:3], 0
    ds_read_b64_tr_b16 a[30:31], v240 offset:14336
    v_cvt_pk_bf16_f32 v99, v102, v103
    v_mfma_f32_16x16x32_bf16 v[188:191], v[64:67], a[0:3], 0
    buffer_store_dwordx4 v[96:99], v241, s[28:31], s54 offen offset:0 sc1
    v_mfma_f32_16x16x32_bf16 v[192:195], v[0:3], a[4:7], 0
    ds_read_b64_tr_b16 a[0:1], v239 offset:16384
    v_accvgpr_read_b32 v104, a116
    v_mfma_f32_16x16x32_bf16 v[196:199], v[32:35], a[4:7], 0
    ds_read_b64_tr_b16 a[2:3], v239 offset:18432
    v_accvgpr_read_b32 v105, a117
    v_mfma_f32_16x16x32_bf16 v[200:203], v[64:67], a[4:7], 0
    v_accvgpr_read_b32 v106, a118
    s_waitcnt lgkmcnt(10)
    v_mfma_f32_16x16x32_bf16 v[180:183], v[4:7], a[8:11], v[180:183]
    ds_read_b64_tr_b16 a[4:5], v240 offset:16384
    v_cvt_pk_bf16_f32 v150, v204, v205
    v_mfma_f32_16x16x32_bf16 v[184:187], v[36:39], a[8:11], v[184:187]
    ds_read_b64_tr_b16 a[6:7], v240 offset:18432
    v_cvt_pk_bf16_f32 v151, v206, v207
    v_mfma_f32_16x16x32_bf16 v[188:191], v[68:71], a[8:11], v[188:191]
    v_cvt_pk_bf16_f32 v152, v208, v209
    v_cvt_pk_bf16_f32 v153, v210, v211
    v_mfma_f32_16x16x32_bf16 v[192:195], v[4:7], a[12:15], v[192:195]
    ds_read_b64_tr_b16 a[8:9], v239 offset:20480
    v_cvt_pk_bf16_f32 v158, v212, v213
    v_mfma_f32_16x16x32_bf16 v[196:199], v[36:39], a[12:15], v[196:199]
    ds_read_b64_tr_b16 a[10:11], v239 offset:22528
    v_cvt_pk_bf16_f32 v159, v214, v215
    v_mfma_f32_16x16x32_bf16 v[200:203], v[68:71], a[12:15], v[200:203]
    v_cvt_pk_bf16_f32 v154, v216, v217
    s_waitcnt lgkmcnt(10)
    v_mfma_f32_16x16x32_bf16 v[180:183], v[8:11], a[16:19], v[180:183]
    ds_read_b64_tr_b16 a[12:13], v240 offset:20480
    v_cvt_pk_bf16_f32 v155, v218, v219
    v_mfma_f32_16x16x32_bf16 v[184:187], v[40:43], a[16:19], v[184:187]
    ds_read_b64_tr_b16 a[14:15], v240 offset:22528
    v_cvt_pk_bf16_f32 v156, v220, v221
    v_mfma_f32_16x16x32_bf16 v[188:191], v[72:75], a[16:19], v[188:191]
    v_cvt_pk_bf16_f32 v157, v222, v223
    v_cvt_pk_bf16_f32 v160, v224, v225
    v_mfma_f32_16x16x32_bf16 v[192:195], v[8:11], a[20:23], v[192:195]
    ds_read_b64_tr_b16 a[16:17], v239 offset:24576
    v_cvt_pk_bf16_f32 v161, v226, v227
    v_mfma_f32_16x16x32_bf16 v[196:199], v[40:43], a[20:23], v[196:199]
    ds_read_b64_tr_b16 a[18:19], v239 offset:26624
    v_accvgpr_write_b32 a234, v158
    v_mfma_f32_16x16x32_bf16 v[200:203], v[72:75], a[20:23], v[200:203]
    v_accvgpr_write_b32 a235, v159
    s_waitcnt lgkmcnt(10)
    v_mfma_f32_16x16x32_bf16 v[180:183], v[12:15], a[24:27], v[180:183]
    ds_read_b64_tr_b16 a[20:21], v240 offset:24576
    v_accvgpr_write_b32 a238, v160
    v_mfma_f32_16x16x32_bf16 v[184:187], v[44:47], a[24:27], v[184:187]
    ds_read_b64_tr_b16 a[22:23], v240 offset:26624
    v_accvgpr_write_b32 a239, v161
    v_mfma_f32_16x16x32_bf16 v[188:191], v[76:79], a[24:27], v[188:191]
    v_accvgpr_read_b32 v107, a119
    v_accvgpr_read_b32 v108, a128
    v_mfma_f32_16x16x32_bf16 a[136:139], v[150:153], v[126:129], a[136:139]
    v_accvgpr_read_b32 v109, a129
    v_accvgpr_read_b32 v110, a130
    v_mfma_f32_16x16x32_bf16 a[140:143], v[150:153], v[130:133], a[140:143]
    v_accvgpr_read_b32 v111, a131
    v_cvt_pk_bf16_f32 v104, v104, v105
    v_mfma_f32_16x16x32_bf16 a[144:147], v[150:153], v[134:137], a[144:147]
    v_cvt_pk_bf16_f32 v105, v106, v107
    v_cvt_pk_bf16_f32 v106, v108, v109
    v_mfma_f32_16x16x32_bf16 a[148:151], v[154:157], v[126:129], a[148:151]
    v_cvt_pk_bf16_f32 v107, v110, v111
    v_accvgpr_read_b32 v112, a120
    v_mfma_f32_16x16x32_bf16 a[152:155], v[154:157], v[130:133], a[152:155]
    buffer_store_dwordx4 v[104:107], v241, s[28:31], s54 offen offset:1024 sc1
    v_mfma_f32_16x16x32_bf16 a[156:159], v[154:157], v[134:137], a[156:159]
    v_accvgpr_read_b32 v113, a121
    v_accvgpr_read_b32 v114, a122
    v_mfma_f32_16x16x32_bf16 v[192:195], v[12:15], a[28:31], v[192:195]
    ds_read_b64_tr_b16 a[24:25], v239 offset:28672
    v_accvgpr_read_b32 v115, a123
    v_mfma_f32_16x16x32_bf16 v[196:199], v[44:47], a[28:31], v[196:199]
    ds_read_b64_tr_b16 a[26:27], v239 offset:30720
    v_accvgpr_read_b32 v116, a132
    v_mfma_f32_16x16x32_bf16 v[200:203], v[76:79], a[28:31], v[200:203]
    v_accvgpr_read_b32 v117, a133
    s_waitcnt lgkmcnt(10)
    v_mfma_f32_16x16x32_bf16 v[180:183], v[16:19], a[0:3], v[180:183]
    ds_read_b64_tr_b16 a[28:29], v240 offset:28672
    v_accvgpr_read_b32 v118, a134
    v_mfma_f32_16x16x32_bf16 v[184:187], v[48:51], a[0:3], v[184:187]
    ds_read_b64_tr_b16 a[30:31], v240 offset:30720
    v_accvgpr_read_b32 v119, a135
    v_mfma_f32_16x16x32_bf16 v[188:191], v[80:83], a[0:3], v[188:191]
    v_cvt_pk_bf16_f32 v112, v112, v113
    v_cvt_pk_bf16_f32 v113, v114, v115
    v_mfma_f32_16x16x32_bf16 a[136:139], a[232:235], v[138:141], a[136:139]
    v_cvt_pk_bf16_f32 v114, v116, v117
    v_cvt_pk_bf16_f32 v115, v118, v119
    v_mfma_f32_16x16x32_bf16 a[140:143], a[232:235], v[142:145], a[140:143]
    buffer_store_dwordx4 v[112:115], v241, s[28:31], s54 offen offset:2048 sc1
    v_mfma_f32_16x16x32_bf16 a[144:147], a[232:235], v[146:149], a[144:147]
    v_mfma_f32_16x16x32_bf16 a[148:151], a[236:239], v[138:141], a[148:151]
    v_mfma_f32_16x16x32_bf16 a[152:155], a[236:239], v[142:145], a[152:155]
    v_mfma_f32_16x16x32_bf16 a[156:159], a[236:239], v[146:149], a[156:159]
    v_mfma_f32_16x16x32_bf16 v[192:195], v[16:19], a[4:7], v[192:195]
    v_mfma_f32_16x16x32_bf16 v[196:199], v[48:51], a[4:7], v[196:199]
    v_mfma_f32_16x16x32_bf16 v[200:203], v[80:83], a[4:7], v[200:203]
    s_waitcnt lgkmcnt(8)
    v_mfma_f32_16x16x32_bf16 v[180:183], v[20:23], a[8:11], v[180:183]
    v_mfma_f32_16x16x32_bf16 v[184:187], v[52:55], a[8:11], v[184:187]
    v_mfma_f32_16x16x32_bf16 v[188:191], v[84:87], a[8:11], v[188:191]
    s_waitcnt vmcnt(6) lgkmcnt(0)
    s_barrier
    v_mfma_f32_16x16x32_bf16 v[192:195], v[20:23], a[12:15], v[192:195]
    ds_read_b64_tr_b16 a[0:1], v237 offset:0
    v_mfma_f32_16x16x32_bf16 v[196:199], v[52:55], a[12:15], v[196:199]
    ds_read_b64_tr_b16 a[2:3], v237 offset:2048
    v_mfma_f32_16x16x32_bf16 v[200:203], v[84:87], a[12:15], v[200:203]
    ds_read_b64_tr_b16 a[4:5], v238 offset:0
    v_mfma_f32_16x16x32_bf16 v[180:183], v[24:27], a[16:19], v[180:183]
    ds_read_b64_tr_b16 a[6:7], v238 offset:2048
    s_add_u32 s54, s52, 24576
    v_mfma_f32_16x16x32_bf16 v[184:187], v[56:59], a[16:19], v[184:187]
    ds_read_b64_tr_b16 a[8:9], v237 offset:4096
    v_accvgpr_read_b32 v96, a136
    v_mfma_f32_16x16x32_bf16 v[188:191], v[88:91], a[16:19], v[188:191]
    ds_read_b64_tr_b16 a[10:11], v237 offset:6144
    v_accvgpr_read_b32 v97, a137
    v_mfma_f32_16x16x32_bf16 v[192:195], v[24:27], a[20:23], v[192:195]
    ds_read_b64_tr_b16 a[12:13], v238 offset:4096
    v_accvgpr_read_b32 v98, a138
    v_mfma_f32_16x16x32_bf16 v[196:199], v[56:59], a[20:23], v[196:199]
    ds_read_b64_tr_b16 a[14:15], v238 offset:6144
    v_accvgpr_read_b32 v99, a139
    v_mfma_f32_16x16x32_bf16 v[200:203], v[88:91], a[20:23], v[200:203]
    ds_read_b64_tr_b16 a[16:17], v237 offset:8192
    v_mfma_f32_16x16x32_bf16 v[180:183], v[28:31], a[24:27], v[180:183]
    ds_read_b64_tr_b16 a[18:19], v237 offset:10240
    v_accvgpr_read_b32 v100, a148
    v_mfma_f32_16x16x32_bf16 v[184:187], v[60:63], a[24:27], v[184:187]
    ds_read_b64_tr_b16 a[20:21], v238 offset:8192
    v_accvgpr_read_b32 v101, a149
    v_mfma_f32_16x16x32_bf16 v[188:191], v[92:95], a[24:27], v[188:191]
    ds_read_b64_tr_b16 a[22:23], v238 offset:10240
    v_accvgpr_read_b32 v102, a150
    v_mfma_f32_16x16x32_bf16 v[192:195], v[28:31], a[28:31], v[192:195]
    ds_read_b64_tr_b16 a[24:25], v237 offset:12288
    v_accvgpr_read_b32 v103, a151
    v_mfma_f32_16x16x32_bf16 v[196:199], v[60:63], a[28:31], v[196:199]
    ds_read_b64_tr_b16 a[26:27], v237 offset:14336
    v_cvt_pk_bf16_f32 v96, v96, v97
    v_mfma_f32_16x16x32_bf16 v[200:203], v[92:95], a[28:31], v[200:203]
    v_cvt_pk_bf16_f32 v97, v98, v99
    s_waitcnt lgkmcnt(10)
    v_mfma_f32_16x16x32_bf16 v[204:207], v[0:3], a[0:3], 0
    ds_read_b64_tr_b16 a[28:29], v238 offset:12288
    v_cvt_pk_bf16_f32 v98, v100, v101
    v_mfma_f32_16x16x32_bf16 v[208:211], v[32:35], a[0:3], 0
    ds_read_b64_tr_b16 a[30:31], v238 offset:14336
    v_cvt_pk_bf16_f32 v99, v102, v103
    v_mfma_f32_16x16x32_bf16 v[212:215], v[64:67], a[0:3], 0
    buffer_store_dwordx4 v[96:99], v241, s[28:31], s54 offen offset:0 sc1
    v_mfma_f32_16x16x32_bf16 v[216:219], v[0:3], a[4:7], 0
    ds_read_b64_tr_b16 a[0:1], v237 offset:16384
    v_accvgpr_read_b32 v104, a140
    v_mfma_f32_16x16x32_bf16 v[220:223], v[32:35], a[4:7], 0
    ds_read_b64_tr_b16 a[2:3], v237 offset:18432
    v_accvgpr_read_b32 v105, a141
    v_mfma_f32_16x16x32_bf16 v[224:227], v[64:67], a[4:7], 0
    v_accvgpr_read_b32 v106, a142
    s_cmp_lg_u32 s32, 0
    s_cbranch_scc1 L_wk_0
    s_mov_b64 exec, 1
    buffer_load_dword v245, v253, s[4:7], s95 offen offset:4 sc1
    s_mov_b64 exec, -1
L_wk_0:
    s_waitcnt lgkmcnt(10)
    v_mfma_f32_16x16x32_bf16 v[204:207], v[4:7], a[8:11], v[204:207]
    ds_read_b64_tr_b16 a[4:5], v238 offset:16384
    v_cvt_pk_bf16_f32 v150, v180, v181
    v_mfma_f32_16x16x32_bf16 v[208:211], v[36:39], a[8:11], v[208:211]
    ds_read_b64_tr_b16 a[6:7], v238 offset:18432
    v_cvt_pk_bf16_f32 v151, v182, v183
    v_mfma_f32_16x16x32_bf16 v[212:215], v[68:71], a[8:11], v[212:215]
    v_cvt_pk_bf16_f32 v152, v184, v185
    v_cvt_pk_bf16_f32 v153, v186, v187
    v_mfma_f32_16x16x32_bf16 v[216:219], v[4:7], a[12:15], v[216:219]
    ds_read_b64_tr_b16 a[8:9], v237 offset:20480
    v_cvt_pk_bf16_f32 v158, v188, v189
    v_mfma_f32_16x16x32_bf16 v[220:223], v[36:39], a[12:15], v[220:223]
    ds_read_b64_tr_b16 a[10:11], v237 offset:22528
    v_cvt_pk_bf16_f32 v159, v190, v191
    v_mfma_f32_16x16x32_bf16 v[224:227], v[68:71], a[12:15], v[224:227]
    v_cvt_pk_bf16_f32 v154, v192, v193
    s_waitcnt lgkmcnt(10)
    v_mfma_f32_16x16x32_bf16 v[204:207], v[8:11], a[16:19], v[204:207]
    ds_read_b64_tr_b16 a[12:13], v238 offset:20480
    v_cvt_pk_bf16_f32 v155, v194, v195
    v_mfma_f32_16x16x32_bf16 v[208:211], v[40:43], a[16:19], v[208:211]
    ds_read_b64_tr_b16 a[14:15], v238 offset:22528
    v_cvt_pk_bf16_f32 v156, v196, v197
    v_mfma_f32_16x16x32_bf16 v[212:215], v[72:75], a[16:19], v[212:215]
    v_cvt_pk_bf16_f32 v157, v198, v199
    v_cvt_pk_bf16_f32 v160, v200, v201
    v_mfma_f32_16x16x32_bf16 v[216:219], v[8:11], a[20:23], v[216:219]
    ds_read_b64_tr_b16 a[16:17], v237 offset:24576
    v_cvt_pk_bf16_f32 v161, v202, v203
    v_mfma_f32_16x16x32_bf16 v[220:223], v[40:43], a[20:23], v[220:223]
    ds_read_b64_tr_b16 a[18:19], v237 offset:26624
    v_accvgpr_write_b32 a242, v158
    v_mfma_f32_16x16x32_bf16 v[224:227], v[72:75], a[20:23], v[224:227]
    v_accvgpr_write_b32 a243, v159
    s_waitcnt lgkmcnt(10)
    v_mfma_f32_16x16x32_bf16 v[204:207], v[12:15], a[24:27], v[204:207]
    ds_read_b64_tr_b16 a[20:21], v238 offset:24576
    v_accvgpr_write_b32 a246, v160
    v_mfma_f32_16x16x32_bf16 v[208:211], v[44:47], a[24:27], v[208:211]
    ds_read_b64_tr_b16 a[22:23], v238 offset:26624
    v_accvgpr_write_b32 a247, v161
    v_mfma_f32_16x16x32_bf16 v[212:215], v[76:79], a[24:27], v[212:215]
    v_accvgpr_read_b32 v107, a143
    v_accvgpr_read_b32 v108, a152
    v_mfma_f32_16x16x32_bf16 a[160:163], v[150:153], v[126:129], a[160:163]
    v_accvgpr_read_b32 v109, a153
    v_accvgpr_read_b32 v110, a154
    v_mfma_f32_16x16x32_bf16 a[164:167], v[150:153], v[130:133], a[164:167]
    v_accvgpr_read_b32 v111, a155
    v_cvt_pk_bf16_f32 v104, v104, v105
    v_mfma_f32_16x16x32_bf16 a[168:171], v[150:153], v[134:137], a[168:171]
    v_cvt_pk_bf16_f32 v105, v106, v107
    v_cvt_pk_bf16_f32 v106, v108, v109
    v_mfma_f32_16x16x32_bf16 a[172:175], v[154:157], v[126:129], a[172:175]
    v_cvt_pk_bf16_f32 v107, v110, v111
    v_accvgpr_read_b32 v112, a144
    v_mfma_f32_16x16x32_bf16 a[176:179], v[154:157], v[130:133], a[176:179]
    buffer_store_dwordx4 v[104:107], v241, s[28:31], s54 offen offset:1024 sc1
    v_mfma_f32_16x16x32_bf16 a[180:183], v[154:157], v[134:137], a[180:183]
    v_accvgpr_read_b32 v113, a145
    v_accvgpr_read_b32 v114, a146
    v_mfma_f32_16x16x32_bf16 v[216:219], v[12:15], a[28:31], v[216:219]
    ds_read_b64_tr_b16 a[24:25], v237 offset:28672
    v_accvgpr_read_b32 v115, a147
    v_mfma_f32_16x16x32_bf16 v[220:223], v[44:47], a[28:31], v[220:223]
    ds_read_b64_tr_b16 a[26:27], v237 offset:30720
    v_accvgpr_read_b32 v116, a156
    v_mfma_f32_16x16x32_bf16 v[224:227], v[76:79], a[28:31], v[224:227]
    v_accvgpr_read_b32 v117, a157
    s_cmp_lg_u32 s32, 0
    s_cbranch_scc1 L_wx_0
    s_mov_b64 exec, 1
    s_mov_b32 s85, 0x40000
    s_waitcnt vmcnt(1)
    v_readfirstlane_b32 s86, v245
    s_nop 3
    s_bfe_u32 s86, s86, 524304
    s_cmp_eq_u32 s86, 8
    s_cbranch_scc1 L_got1_0
L_poll1_0:
    buffer_load_dword v245, v253, s[4:7], s95 offen offset:4 sc1
    s_waitcnt vmcnt(0)
    v_readfirstlane_b32 s86, v245
    s_nop 3
    s_bfe_u32 s86, s86, 524304
    s_cmp_eq_u32 s86, 8
    s_cbranch_scc1 L_got1_0
    s_sleep 2
    s_sub_u32 s85, s85, 1
    s_cmp_lg_u32 s85, 0
    s_cbranch_scc1 L_poll1_0
L_got1_0:
    s_mov_b64 exec, -1
L_wx_0:
    s_waitcnt vmcnt(2)
    s_barrier
    s_cmp_lg_u32 s32, 0
    s_cbranch_scc1 L_wy_0
    s_mov_b64 exec, 1
    v_mov_b32 v254, 256
    buffer_atomic_add v254, v253, s[4:7], s95 offen offset:4
    s_mov_b64 exec, -1
L_wy_0:
    s_waitcnt lgkmcnt(10)
    v_mfma_f32_16x16x32_bf16 v[204:207], v[16:19], a[0:3], v[204:207]
    ds_read_b64_tr_b16 a[28:29], v238 offset:28672
    s_add_u32 s56, s64, 0
    v_mfma_f32_16x16x32_bf16 v[208:211], v[48:51], a[0:3], v[208:211]
    buffer_load_dwordx4 v[180:183], v241, s[28:31], s56 offen sc1
    v_mfma_f32_16x16x32_bf16 v[212:215], v[80:83], a[0:3], v[212:215]
    ds_read_b64_tr_b16 a[30:31], v238 offset:30720
    s_add_u32 s56, s64, 2752512
    v_mfma_f32_16x16x32_bf16 a[160:163], a[240:243], v[138:141], a[160:163]
    buffer_load_dwordx4 v[184:187], v241, s[28:31], s56 offen sc1
    v_mfma_f32_16x16x32_bf16 a[164:167], a[240:243], v[142:145], a[164:167]
    s_add_u32 s56, s64, 5505024
    v_accvgpr_read_b32 v118, a158
    v_mfma_f32_16x16x32_bf16 a[168:171], a[240:243], v[146:149], a[168:171]
    buffer_load_dwordx4 v[188:191], v241, s[28:31], s56 offen sc1
    v_mfma_f32_16x16x32_bf16 a[172:175], a[244:247], v[138:141], a[172:175]
    s_add_u32 s56, s64, 8257536
    v_accvgpr_read_b32 v119, a159
    v_mfma_f32_16x16x32_bf16 a[176:179], a[244:247], v[142:145], a[176:179]
    buffer_load_dwordx4 v[192:195], v241, s[28:31], s56 offen sc1
    v_mfma_f32_16x16x32_bf16 a[180:183], a[244:247], v[146:149], a[180:183]
    s_add_u32 s56, s64, 11010048
    v_cvt_pk_bf16_f32 v112, v112, v113
    v_mfma_f32_16x16x32_bf16 v[216:219], v[16:19], a[4:7], v[216:219]
    buffer_load_dwordx4 v[196:199], v241, s[28:31], s56 offen sc1
    v_mfma_f32_16x16x32_bf16 v[220:223], v[48:51], a[4:7], v[220:223]
    s_add_u32 s56, s64, 13762560
    v_cvt_pk_bf16_f32 v113, v114, v115
    v_mfma_f32_16x16x32_bf16 v[224:227], v[80:83], a[4:7], v[224:227]
    v_cvt_pk_bf16_f32 v114, v116, v117
    s_waitcnt lgkmcnt(8)
    v_mfma_f32_16x16x32_bf16 v[204:207], v[20:23], a[8:11], v[204:207]
    buffer_load_dwordx4 v[200:203], v241, s[28:31], s56 offen sc1
    v_mfma_f32_16x16x32_bf16 v[208:211], v[52:55], a[8:11], v[208:211]
    s_add_u32 s56, s64, 16515072
    v_cvt_pk_bf16_f32 v115, v118, v119
    v_mfma_f32_16x16x32_bf16 v[212:215], v[84:87], a[8:11], v[212:215]
    buffer_load_dwordx4 v[164:167], v241, s[28:31], s56 offen sc1
    v_mfma_f32_16x16x32_bf16 v[216:219], v[20:23], a[12:15], v[216:219]
    s_add_u32 s56, s64, 19267584
    v_mfma_f32_16x16x32_bf16 v[220:223], v[52:55], a[12:15], v[220:223]
    v_mfma_f32_16x16x32_bf16 v[224:227], v[84:87], a[12:15], v[224:227]
    s_waitcnt lgkmcnt(4)
    v_mfma_f32_16x16x32_bf16 v[204:207], v[24:27], a[16:19], v[204:207]
    buffer_load_dwordx4 v[168:171], v241, s[28:31], s56 offen sc1
    v_mfma_f32_16x16x32_bf16 v[208:211], v[56:59], a[16:19], v[208:211]
    v_accvgpr_read_b32 v96, a160
    v_accvgpr_read_b32 v97, a161
    v_mfma_f32_16x16x32_bf16 v[212:215], v[88:91], a[16:19], v[212:215]
    buffer_store_dwordx4 v[112:115], v241, s[28:31], s54 offen offset:2048 sc1
    v_mfma_f32_16x16x32_bf16 v[216:219], v[24:27], a[20:23], v[216:219]
    s_add_u32 s54, s52, 30720
    v_accvgpr_read_b32 v98, a162
    v_mfma_f32_16x16x32_bf16 v[220:223], v[56:59], a[20:23], v[220:223]
    v_accvgpr_read_b32 v99, a163
    v_accvgpr_read_b32 v100, a172
    v_mfma_f32_16x16x32_bf16 v[224:227], v[88:91], a[20:23], v[224:227]
    v_accvgpr_read_b32 v101, a173
    s_waitcnt lgkmcnt(0)
    v_mfma_f32_16x16x32_bf16 v[204:207], v[28:31], a[24:27], v[204:207]
    v_accvgpr_read_b32 v102, a174
    v_accvgpr_read_b32 v103, a175
    v_mfma_f32_16x16x32_bf16 v[208:211], v[60:63], a[24:27], v[208:211]
    v_cvt_pk_bf16_f32 v96, v96, v97
    v_cvt_pk_bf16_f32 v97, v98, v99
    v_mfma_f32_16x16x32_bf16 v[212:215], v[92:95], a[24:27], v[212:215]
    v_cvt_pk_bf16_f32 v98, v100, v101
    v_cvt_pk_bf16_f32 v99, v102, v103
    v_mfma_f32_16x16x32_bf16 v[216:219], v[28:31], a[28:31], v[216:219]
    buffer_store_dwordx4 v[96:99], v241, s[28:31], s54 offen offset:0 sc1
    v_mfma_f32_16x16x32_bf16 v[220:223], v[60:63], a[28:31], v[220:223]
    v_accvgpr_read_b32 v104, a164
    v_accvgpr_read_b32 v105, a165
    v_mfma_f32_16x16x32_bf16 v[224:227], v[92:95], a[28:31], v[224:227]
    v_accvgpr_read_b32 v106, a166
    v_accvgpr_read_b32 v107, a167
    v_accvgpr_read_b32 v108, a176
    v_accvgpr_read_b32 v109, a177
    v_accvgpr_read_b32 v110, a178
    v_accvgpr_read_b32 v111, a179
    v_cvt_pk_bf16_f32 v104, v104, v105
    v_cvt_pk_bf16_f32 v105, v106, v107
    v_cvt_pk_bf16_f32 v106, v108, v109
    v_cvt_pk_bf16_f32 v107, v110, v111
    buffer_store_dwordx4 v[104:107], v241, s[28:31], s54 offen offset:1024 sc1
    v_accvgpr_read_b32 v112, a168
    v_accvgpr_read_b32 v113, a169
    v_accvgpr_read_b32 v114, a170
    v_accvgpr_read_b32 v115, a171
    v_accvgpr_read_b32 v116, a180
    v_accvgpr_read_b32 v117, a181
    v_accvgpr_read_b32 v118, a182
    v_accvgpr_read_b32 v119, a183
    v_cvt_pk_bf16_f32 v112, v112, v113
    v_cvt_pk_bf16_f32 v113, v114, v115
    v_cvt_pk_bf16_f32 v114, v116, v117
    v_cvt_pk_bf16_f32 v115, v118, v119
    buffer_store_dwordx4 v[112:115], v241, s[28:31], s54 offen offset:2048 sc1
    v_cvt_pk_bf16_f32 v150, v204, v205
    v_cvt_pk_bf16_f32 v151, v206, v207
    v_cvt_pk_bf16_f32 v152, v208, v209
    v_cvt_pk_bf16_f32 v153, v210, v211
    v_cvt_pk_bf16_f32 v158, v212, v213
    v_cvt_pk_bf16_f32 v159, v214, v215
    v_cvt_pk_bf16_f32 v154, v216, v217
    v_cvt_pk_bf16_f32 v155, v218, v219
    v_cvt_pk_bf16_f32 v156, v220, v221
    v_cvt_pk_bf16_f32 v157, v222, v223
    v_cvt_pk_bf16_f32 v160, v224, v225
    v_cvt_pk_bf16_f32 v161, v226, v227
    v_accvgpr_write_b32 a250, v158
    v_accvgpr_write_b32 a251, v159
    v_accvgpr_write_b32 a254, v160
    v_accvgpr_write_b32 a255, v161
    v_mfma_f32_16x16x32_bf16 a[184:187], v[150:153], v[126:129], a[184:187]
    v_mfma_f32_16x16x32_bf16 a[188:191], v[150:153], v[130:133], a[188:191]
    v_mfma_f32_16x16x32_bf16 a[192:195], v[150:153], v[134:137], a[192:195]
    v_mfma_f32_16x16x32_bf16 a[196:199], v[154:157], v[126:129], a[196:199]
    v_mfma_f32_16x16x32_bf16 a[200:203], v[154:157], v[130:133], a[200:203]
    v_mfma_f32_16x16x32_bf16 a[204:207], v[154:157], v[134:137], a[204:207]
    v_mfma_f32_16x16x32_bf16 a[184:187], a[248:251], v[138:141], a[184:187]
    v_mfma_f32_16x16x32_bf16 a[188:191], a[248:251], v[142:145], a[188:191]
    v_mfma_f32_16x16x32_bf16 a[192:195], a[248:251], v[146:149], a[192:195]
    v_mfma_f32_16x16x32_bf16 a[196:199], a[252:255], v[138:141], a[196:199]
    v_mfma_f32_16x16x32_bf16 a[200:203], a[252:255], v[142:145], a[200:203]
    v_mfma_f32_16x16x32_bf16 a[204:207], a[252:255], v[146:149], a[204:207]
    s_add_u32 s54, s52, 36864
    s_nop 1
    v_accvgpr_read_b32 v96, a184
    v_accvgpr_read_b32 v97, a185
    v_accvgpr_read_b32 v98, a186
    v_accvgpr_read_b32 v99, a187
    v_accvgpr_read_b32 v100, a196
    v_accvgpr_read_b32 v101, a197
    v_accvgpr_read_b32 v102, a198
    v_accvgpr_read_b32 v103, a199
    v_cvt_pk_bf16_f32 v96, v96, v97
    v_cvt_pk_bf16_f32 v97, v98, v99
    v_cvt_pk_bf16_f32 v98, v100, v101
    v_cvt_pk_bf16_f32 v99, v102, v103
    buffer_store_dwordx4 v[96:99], v241, s[28:31], s54 offen offset:0 sc1
    v_accvgpr_read_b32 v104, a188
    v_accvgpr_read_b32 v105, a189
    v_accvgpr_read_b32 v106, a190
    v_accvgpr_read_b32 v107, a191
    v_accvgpr_read_b32 v108, a200
    v_accvgpr_read_b32 v109, a201
    v_accvgpr_read_b32 v110, a202
    v_accvgpr_read_b32 v111, a203
    v_cvt_pk_bf16_f32 v104, v104, v105
    v_cvt_pk_bf16_f32 v105, v106, v107
    v_cvt_pk_bf16_f32 v106, v108, v109
    v_cvt_pk_bf16_f32 v107, v110, v111
    buffer_store_dwordx4 v[104:107], v241, s[28:31], s54 offen offset:1024 sc1
    v_accvgpr_read_b32 v112, a192
    v_accvgpr_read_b32 v113, a193
    v_accvgpr_read_b32 v114, a194
    v_accvgpr_read_b32 v115, a195
    v_accvgpr_read_b32 v116, a204
    v_accvgpr_read_b32 v117, a205
    v_accvgpr_read_b32 v118, a206
    v_accvgpr_read_b32 v119, a207
    v_cvt_pk_bf16_f32 v112, v112, v113
    v_cvt_pk_bf16_f32 v113, v114, v115
    v_cvt_pk_bf16_f32 v114, v116, v117
    v_cvt_pk_bf16_f32 v115, v118, v119
    buffer_store_dwordx4 v[112:115], v241, s[28:31], s54 offen offset:2048 sc1
    v_lshrrev_b32 v173, 4, v241
    v_and_b32 v172, 15, v173
    v_mul_u32_u24 v172, 1792, v172
    v_lshrrev_b32 v173, 4, v173
    v_lshl_add_u32 v172, v173, 4, v172
    s_cmp_lg_u32 s32, 0
    s_cbranch_scc1 L_w1_0
    s_mov_b64 exec, 1
    s_mov_b32 s85, 0x40000
L_poll2_0:
    buffer_load_dword v245, v253, s[4:7], s95 offen offset:4 sc1
    s_waitcnt vmcnt(0)
    v_readfirstlane_b32 s86, v245
    s_nop 3
    s_bfe_u32 s86, s86, 524296
    s_cmp_eq_u32 s86, 8
    s_cbranch_scc1 L_got2_0
    s_sleep 2
    s_sub_u32 s85, s85, 1
    s_cmp_lg_u32 s85, 0
    s_cbranch_scc1 L_poll2_0
L_got2_0:
    s_mov_b64 exec, -1
L_w1_0:
    s_waitcnt vmcnt(0)
    s_barrier
    s_cmp_lg_u32 s32, 0
    s_cbranch_scc1 L_w2_0
    s_mov_b64 exec, 1
    v_mov_b32 v254, 1
    buffer_atomic_add v254, v253, s[4:7], s95 offen offset:4
    s_mov_b64 exec, -1
L_w2_0:
    s_add_u32 s56, s65, 0
    buffer_load_dwordx4 v[32:35], v241, s[28:31], s56 offen sc1
    s_add_u32 s56, s65, 2752512
    buffer_load_dwordx4 v[36:39], v241, s[28:31], s56 offen sc1
    s_add_u32 s56, s65, 5505024
    buffer_load_dwordx4 v[40:43], v241, s[28:31], s56 offen sc1
    s_add_u32 s56, s65, 8257536
    buffer_load_dwordx4 v[44:47], v241, s[28:31], s56 offen sc1
    s_add_u32 s56, s65, 11010048
    buffer_load_dwordx4 v[48:51], v241, s[28:31], s56 offen sc1
    s_add_u32 s56, s65, 13762560
    buffer_load_dwordx4 v[52:55], v241, s[28:31], s56 offen sc1
    s_add_u32 s56, s65, 16515072
    buffer_load_dwordx4 v[56:59], v241, s[28:31], s56 offen sc1
    s_add_u32 s56, s65, 19267584
    buffer_load_dwordx4 v[60:63], v241, s[28:31], s56 offen sc1
    v_lshlrev_b32 v100, 16, v180
    v_and_b32 v101, 0xffff0000, v180
    v_lshlrev_b32 v102, 16, v181
    v_and_b32 v103, 0xffff0000, v181
    v_lshlrev_b32 v104, 16, v182
    v_and_b32 v105, 0xffff0000, v182
    v_lshlrev_b32 v106, 16, v183
    v_and_b32 v107, 0xffff0000, v183
    v_lshlrev_b32 v108, 16, v184
    v_and_b32 v109, 0xffff0000, v184
    v_lshlrev_b32 v110, 16, v185
    v_and_b32 v111, 0xffff0000, v185
    v_lshlrev_b32 v112, 16, v186
    v_and_b32 v113, 0xffff0000, v186
    v_lshlrev_b32 v114, 16, v187
    v_and_b32 v115, 0xffff0000, v187
    v_add_f32 v100, v100, v108
    v_add_f32 v101, v101, v109
    v_add_f32 v102, v102, v110
    v_add_f32 v103, v103, v111
    v_add_f32 v104, v104, v112
    v_add_f32 v105, v105, v113
    v_add_f32 v106, v106, v114
    v_add_f32 v107, v107, v115
    v_lshlrev_b32 v108, 16, v188
    v_and_b32 v109, 0xffff0000, v188
    v_lshlrev_b32 v110, 16, v189
    v_and_b32 v111, 0xffff0000, v189
    v_lshlrev_b32 v112, 16, v190
    v_and_b32 v113, 0xffff0000, v190
    v_lshlrev_b32 v114, 16, v191
    v_and_b32 v115, 0xffff0000, v191
    v_add_f32 v100, v100, v108
    v_add_f32 v101, v101, v109
    v_add_f32 v102, v102, v110
    v_add_f32 v103, v103, v111
    v_add_f32 v104, v104, v112
    v_add_f32 v105, v105, v113
    v_add_f32 v106, v106, v114
    v_add_f32 v107, v107, v115
    v_lshlrev_b32 v108, 16, v192
    v_and_b32 v109, 0xffff0000, v192
    v_lshlrev_b32 v110, 16, v193
    v_and_b32 v111, 0xffff0000, v193
    v_lshlrev_b32 v112, 16, v194
    v_and_b32 v113, 0xffff0000, v194
    v_lshlrev_b32 v114, 16, v195
    v_and_b32 v115, 0xffff0000, v195
    v_add_f32 v100, v100, v108
    v_add_f32 v101, v101, v109
    v_add_f32 v102, v102, v110
    v_add_f32 v103, v103, v111
    v_add_f32 v104, v104, v112
    v_add_f32 v105, v105, v113
    v_add_f32 v106, v106, v114
    v_add_f32 v107, v107, v115
    v_lshlrev_b32 v108, 16, v196
    v_and_b32 v109, 0xffff0000, v196
    v_lshlrev_b32 v110, 16, v197
    v_and_b32 v111, 0xffff0000, v197
    v_lshlrev_b32 v112, 16, v198
    v_and_b32 v113, 0xffff0000, v198
    v_lshlrev_b32 v114, 16, v199
    v_and_b32 v115, 0xffff0000, v199
    v_add_f32 v100, v100, v108
    v_add_f32 v101, v101, v109
    v_add_f32 v102, v102, v110
    v_add_f32 v103, v103, v111
    v_add_f32 v104, v104, v112
    v_add_f32 v105, v105, v113
    v_add_f32 v106, v106, v114
    v_add_f32 v107, v107, v115
    v_lshlrev_b32 v108, 16, v200
    v_and_b32 v109, 0xffff0000, v200
    v_lshlrev_b32 v110, 16, v201
    v_and_b32 v111, 0xffff0000, v201
    v_lshlrev_b32 v112, 16, v202
    v_and_b32 v113, 0xffff0000, v202
    v_lshlrev_b32 v114, 16, v203
    v_and_b32 v115, 0xffff0000, v203
    v_add_f32 v100, v100, v108
    v_add_f32 v101, v101, v109
    v_add_f32 v102, v102, v110
    v_add_f32 v103, v103, v111
    v_add_f32 v104, v104, v112
    v_add_f32 v105, v105, v113
    v_add_f32 v106, v106, v114
    v_add_f32 v107, v107, v115
    v_lshlrev_b32 v108, 16, v164
    v_and_b32 v109, 0xffff0000, v164
    v_lshlrev_b32 v110, 16, v165
    v_and_b32 v111, 0xffff0000, v165
    v_lshlrev_b32 v112, 16, v166
    v_and_b32 v113, 0xffff0000, v166
    v_lshlrev_b32 v114, 16, v167
    v_and_b32 v115, 0xffff0000, v167
    v_add_f32 v100, v100, v108
    v_add_f32 v101, v101, v109
    v_add_f32 v102, v102, v110
    v_add_f32 v103, v103, v111
    v_add_f32 v104, v104, v112
    v_add_f32 v105, v105, v113
    v_add_f32 v106, v106, v114
    v_add_f32 v107, v107, v115
    v_lshlrev_b32 v108, 16, v168
    v_and_b32 v109, 0xffff0000, v168
    v_lshlrev_b32 v110, 16, v169
    v_and_b32 v111, 0xffff0000, v169
    v_lshlrev_b32 v112, 16, v170
    v_and_b32 v113, 0xffff0000, v170
    v_lshlrev_b32 v114, 16, v171
    v_and_b32 v115, 0xffff0000, v171
    v_add_f32 v100, v100, v108
    v_add_f32 v101, v101, v109
    v_add_f32 v102, v102, v110
    v_add_f32 v103, v103, v111
    v_add_f32 v104, v104, v112
    v_add_f32 v105, v105, v113
    v_add_f32 v106, v106, v114
    v_add_f32 v107, v107, v115
    v_cvt_pk_bf16_f32 v116, v100, v101
    v_cvt_pk_bf16_f32 v117, v102, v103
    v_cvt_pk_bf16_f32 v118, v104, v105
    v_cvt_pk_bf16_f32 v119, v106, v107
    s_nop 0
    v_permlane32_swap_b32 v116, v118
    v_permlane32_swap_b32 v117, v119
    s_nop 0
    v_permlane16_swap_b32 v116, v118
    v_permlane16_swap_b32 v117, v119
    buffer_store_dwordx4 v[116:119], v172, s[76:79], s68 offen
    s_waitcnt vmcnt(8)
    v_lshlrev_b32 v120, 16, v32
    v_and_b32 v121, 0xffff0000, v32
    v_lshlrev_b32 v122, 16, v33
    v_and_b32 v123, 0xffff0000, v33
    v_lshlrev_b32 v124, 16, v34
    v_and_b32 v125, 0xffff0000, v34
    v_lshlrev_b32 v126, 16, v35
    v_and_b32 v127, 0xffff0000, v35
    s_waitcnt vmcnt(7)
    v_lshlrev_b32 v128, 16, v36
    v_and_b32 v129, 0xffff0000, v36
    v_lshlrev_b32 v130, 16, v37
    v_and_b32 v131, 0xffff0000, v37
    v_lshlrev_b32 v132, 16, v38
    v_and_b32 v133, 0xffff0000, v38
    v_lshlrev_b32 v134, 16, v39
    v_and_b32 v135, 0xffff0000, v39
    v_add_f32 v120, v120, v128
    v_add_f32 v121, v121, v129
    v_add_f32 v122, v122, v130
    v_add_f32 v123, v123, v131
    v_add_f32 v124, v124, v132
    v_add_f32 v125, v125, v133
    v_add_f32 v126, v126, v134
    v_add_f32 v127, v127, v135
    s_waitcnt vmcnt(6)
    v_lshlrev_b32 v128, 16, v40
    v_and_b32 v129, 0xffff0000, v40
    v_lshlrev_b32 v130, 16, v41
    v_and_b32 v131, 0xffff0000, v41
    v_lshlrev_b32 v132, 16, v42
    v_and_b32 v133, 0xffff0000, v42
    v_lshlrev_b32 v134, 16, v43
    v_and_b32 v135, 0xffff0000, v43
    v_add_f32 v120, v120, v128
    v_add_f32 v121, v121, v129
    v_add_f32 v122, v122, v130
    v_add_f32 v123, v123, v131
    v_add_f32 v124, v124, v132
    v_add_f32 v125, v125, v133
    v_add_f32 v126, v126, v134
    v_add_f32 v127, v127, v135
    s_waitcnt vmcnt(5)
    v_lshlrev_b32 v128, 16, v44
    v_and_b32 v129, 0xffff0000, v44
    v_lshlrev_b32 v130, 16, v45
    v_and_b32 v131, 0xffff0000, v45
    v_lshlrev_b32 v132, 16, v46
    v_and_b32 v133, 0xffff0000, v46
    v_lshlrev_b32 v134, 16, v47
    v_and_b32 v135, 0xffff0000, v47
    v_add_f32 v120, v120, v128
    v_add_f32 v121, v121, v129
    v_add_f32 v122, v122, v130
    v_add_f32 v123, v123, v131
    v_add_f32 v124, v124, v132
    v_add_f32 v125, v125, v133
    v_add_f32 v126, v126, v134
    v_add_f32 v127, v127, v135
    s_waitcnt vmcnt(4)
    v_lshlrev_b32 v128, 16, v48
    v_and_b32 v129, 0xffff0000, v48
    v_lshlrev_b32 v130, 16, v49
    v_and_b32 v131, 0xffff0000, v49
    v_lshlrev_b32 v132, 16, v50
    v_and_b32 v133, 0xffff0000, v50
    v_lshlrev_b32 v134, 16, v51
    v_and_b32 v135, 0xffff0000, v51
    v_add_f32 v120, v120, v128
    v_add_f32 v121, v121, v129
    v_add_f32 v122, v122, v130
    v_add_f32 v123, v123, v131
    v_add_f32 v124, v124, v132
    v_add_f32 v125, v125, v133
    v_add_f32 v126, v126, v134
    v_add_f32 v127, v127, v135
    s_waitcnt vmcnt(3)
    v_lshlrev_b32 v128, 16, v52
    v_and_b32 v129, 0xffff0000, v52
    v_lshlrev_b32 v130, 16, v53
    v_and_b32 v131, 0xffff0000, v53
    v_lshlrev_b32 v132, 16, v54
    v_and_b32 v133, 0xffff0000, v54
    v_lshlrev_b32 v134, 16, v55
    v_and_b32 v135, 0xffff0000, v55
    v_add_f32 v120, v120, v128
    v_add_f32 v121, v121, v129
    v_add_f32 v122, v122, v130
    v_add_f32 v123, v123, v131
    v_add_f32 v124, v124, v132
    v_add_f32 v125, v125, v133
    v_add_f32 v126, v126, v134
    v_add_f32 v127, v127, v135
    s_waitcnt vmcnt(2)
    v_lshlrev_b32 v128, 16, v56
    v_and_b32 v129, 0xffff0000, v56
    v_lshlrev_b32 v130, 16, v57
    v_and_b32 v131, 0xffff0000, v57
    v_lshlrev_b32 v132, 16, v58
    v_and_b32 v133, 0xffff0000, v58
    v_lshlrev_b32 v134, 16, v59
    v_and_b32 v135, 0xffff0000, v59
    v_add_f32 v120, v120, v128
    v_add_f32 v121, v121, v129
    v_add_f32 v122, v122, v130
    v_add_f32 v123, v123, v131
    v_add_f32 v124, v124, v132
    v_add_f32 v125, v125, v133
    v_add_f32 v126, v126, v134
    v_add_f32 v127, v127, v135
    s_waitcnt vmcnt(1)
    v_lshlrev_b32 v128, 16, v60
    v_and_b32 v129, 0xffff0000, v60
    v_lshlrev_b32 v130, 16, v61
    v_and_b32 v131, 0xffff0000, v61
    v_lshlrev_b32 v132, 16, v62
    v_and_b32 v133, 0xffff0000, v62
    v_lshlrev_b32 v134, 16, v63
    v_and_b32 v135, 0xffff0000, v63
    v_add_f32 v120, v120, v128
    v_add_f32 v121, v121, v129
    v_add_f32 v122, v122, v130
    v_add_f32 v123, v123, v131
    v_add_f32 v124, v124, v132
    v_add_f32 v125, v125, v133
    v_add_f32 v126, v126, v134
    v_add_f32 v127, v127, v135
    v_cvt_pk_bf16_f32 v136, v120, v121
    v_cvt_pk_bf16_f32 v137, v122, v123
    v_cvt_pk_bf16_f32 v138, v124, v125
    v_cvt_pk_bf16_f32 v139, v126, v127
    s_nop 0
    v_permlane32_swap_b32 v136, v138
    v_permlane32_swap_b32 v137, v139
    s_nop 0
    v_permlane16_swap_b32 v136, v138
    v_permlane16_swap_b32 v137, v139
    buffer_store_dwordx4 v[136:139], v172, s[76:79], s69 offen
    s_cmp_lg_u32 s32, 0
    s_cbranch_scc1 L_w4_0
    s_mov_b64 exec, 1
    s_mov_b32 s85, 0x40000
L_poll3_0:
    buffer_load_dword v245, v253, s[4:7], s95 offen offset:4 sc1
    s_waitcnt vmcnt(0)
    v_readfirstlane_b32 s86, v245
    s_nop 3
    s_bfe_u32 s86, s86, 524288
    s_cmp_eq_u32 s86, 8
    s_cbranch_scc1 L_got3_0
    s_sleep 2
    s_sub_u32 s85, s85, 1
    s_cmp_lg_u32 s85, 0
    s_cbranch_scc1 L_poll3_0
L_got3_0:
    s_mov_b64 exec, -1
L_w4_0:
    s_barrier
    s_add_u32 s56, s66, 0
    buffer_load_dwordx4 v[0:3], v241, s[28:31], s56 offen sc1
    s_add_u32 s56, s66, 2752512
    buffer_load_dwordx4 v[4:7], v241, s[28:31], s56 offen sc1
    s_add_u32 s56, s66, 5505024
    buffer_load_dwordx4 v[8:11], v241, s[28:31], s56 offen sc1
    s_add_u32 s56, s66, 8257536
    buffer_load_dwordx4 v[12:15], v241, s[28:31], s56 offen sc1
    s_add_u32 s56, s66, 11010048
    buffer_load_dwordx4 v[16:19], v241, s[28:31], s56 offen sc1
    s_add_u32 s56, s66, 13762560
    buffer_load_dwordx4 v[20:23], v241, s[28:31], s56 offen sc1
    s_add_u32 s56, s66, 16515072
    buffer_load_dwordx4 v[24:27], v241, s[28:31], s56 offen sc1
    s_add_u32 s56, s66, 19267584
    buffer_load_dwordx4 v[28:31], v241, s[28:31], s56 offen sc1
    s_add_u32 s56, s67, 0
    buffer_load_dwordx4 v[32:35], v241, s[28:31], s56 offen sc1
    s_add_u32 s56, s67, 2752512
    buffer_load_dwordx4 v[36:39], v241, s[28:31], s56 offen sc1
    s_add_u32 s56, s67, 5505024
    buffer_load_dwordx4 v[40:43], v241, s[28:31], s56 offen sc1
    s_add_u32 s56, s67, 8257536
    buffer_load_dwordx4 v[44:47], v241, s[28:31], s56 offen sc1
    s_add_u32 s56, s67, 11010048
    buffer_load_dwordx4 v[48:51], v241, s[28:31], s56 offen sc1
    s_add_u32 s56, s67, 13762560
    buffer_load_dwordx4 v[52:55], v241, s[28:31], s56 offen sc1
    s_add_u32 s56, s67, 16515072
    buffer_load_dwordx4 v[56:59], v241, s[28:31], s56 offen sc1
    s_add_u32 s56, s67, 19267584
    buffer_load_dwordx4 v[60:63], v241, s[28:31], s56 offen sc1
    s_waitcnt vmcnt(15)
    v_lshlrev_b32 v100, 16, v0
    v_and_b32 v101, 0xffff0000, v0
    v_lshlrev_b32 v102, 16, v1
    v_and_b32 v103, 0xffff0000, v1
    v_lshlrev_b32 v104, 16, v2
    v_and_b32 v105, 0xffff0000, v2
    v_lshlrev_b32 v106, 16, v3
    v_and_b32 v107, 0xffff0000, v3
    s_waitcnt vmcnt(14)
    v_lshlrev_b32 v108, 16, v4
    v_and_b32 v109, 0xffff0000, v4
    v_lshlrev_b32 v110, 16, v5
    v_and_b32 v111, 0xffff0000, v5
    v_lshlrev_b32 v112, 16, v6
    v_and_b32 v113, 0xffff0000, v6
    v_lshlrev_b32 v114, 16, v7
    v_and_b32 v115, 0xffff0000, v7
    v_add_f32 v100, v100, v108
    v_add_f32 v101, v101, v109
    v_add_f32 v102, v102, v110
    v_add_f32 v103, v103, v111
    v_add_f32 v104, v104, v112
    v_add_f32 v105, v105, v113
    v_add_f32 v106, v106, v114
    v_add_f32 v107, v107, v115
    s_waitcnt vmcnt(13)
    v_lshlrev_b32 v108, 16, v8
    v_and_b32 v109, 0xffff0000, v8
    v_lshlrev_b32 v110, 16, v9
    v_and_b32 v111, 0xffff0000, v9
    v_lshlrev_b32 v112, 16, v10
    v_and_b32 v113, 0xffff0000, v10
    v_lshlrev_b32 v114, 16, v11
    v_and_b32 v115, 0xffff0000, v11
    v_add_f32 v100, v100, v108
    v_add_f32 v101, v101, v109
    v_add_f32 v102, v102, v110
    v_add_f32 v103, v103, v111
    v_add_f32 v104, v104, v112
    v_add_f32 v105, v105, v113
    v_add_f32 v106, v106, v114
    v_add_f32 v107, v107, v115
    s_waitcnt vmcnt(12)
    v_lshlrev_b32 v108, 16, v12
    v_and_b32 v109, 0xffff0000, v12
    v_lshlrev_b32 v110, 16, v13
    v_and_b32 v111, 0xffff0000, v13
    v_lshlrev_b32 v112, 16, v14
    v_and_b32 v113, 0xffff0000, v14
    v_lshlrev_b32 v114, 16, v15
    v_and_b32 v115, 0xffff0000, v15
    v_add_f32 v100, v100, v108
    v_add_f32 v101, v101, v109
    v_add_f32 v102, v102, v110
    v_add_f32 v103, v103, v111
    v_add_f32 v104, v104, v112
    v_add_f32 v105, v105, v113
    v_add_f32 v106, v106, v114
    v_add_f32 v107, v107, v115
    s_waitcnt vmcnt(11)
    v_lshlrev_b32 v108, 16, v16
    v_and_b32 v109, 0xffff0000, v16
    v_lshlrev_b32 v110, 16, v17
    v_and_b32 v111, 0xffff0000, v17
    v_lshlrev_b32 v112, 16, v18
    v_and_b32 v113, 0xffff0000, v18
    v_lshlrev_b32 v114, 16, v19
    v_and_b32 v115, 0xffff0000, v19
    v_add_f32 v100, v100, v108
    v_add_f32 v101, v101, v109
    v_add_f32 v102, v102, v110
    v_add_f32 v103, v103, v111
    v_add_f32 v104, v104, v112
    v_add_f32 v105, v105, v113
    v_add_f32 v106, v106, v114
    v_add_f32 v107, v107, v115
    s_waitcnt vmcnt(10)
    v_lshlrev_b32 v108, 16, v20
    v_and_b32 v109, 0xffff0000, v20
    v_lshlrev_b32 v110, 16, v21
    v_and_b32 v111, 0xffff0000, v21
    v_lshlrev_b32 v112, 16, v22
    v_and_b32 v113, 0xffff0000, v22
    v_lshlrev_b32 v114, 16, v23
    v_and_b32 v115, 0xffff0000, v23
    v_add_f32 v100, v100, v108
    v_add_f32 v101, v101, v109
    v_add_f32 v102, v102, v110
    v_add_f32 v103, v103, v111
    v_add_f32 v104, v104, v112
    v_add_f32 v105, v105, v113
    v_add_f32 v106, v106, v114
    v_add_f32 v107, v107, v115
    s_waitcnt vmcnt(9)
    v_lshlrev_b32 v108, 16, v24
    v_and_b32 v109, 0xffff0000, v24
    v_lshlrev_b32 v110, 16, v25
    v_and_b32 v111, 0xffff0000, v25
    v_lshlrev_b32 v112, 16, v26
    v_and_b32 v113, 0xffff0000, v26
    v_lshlrev_b32 v114, 16, v27
    v_and_b32 v115, 0xffff0000, v27
    v_add_f32 v100, v100, v108
    v_add_f32 v101, v101, v109
    v_add_f32 v102, v102, v110
    v_add_f32 v103, v103, v111
    v_add_f32 v104, v104, v112
    v_add_f32 v105, v105, v113
    v_add_f32 v106, v106, v114
    v_add_f32 v107, v107, v115
    s_waitcnt vmcnt(8)
    v_lshlrev_b32 v108, 16, v28
    v_and_b32 v109, 0xffff0000, v28
    v_lshlrev_b32 v110, 16, v29
    v_and_b32 v111, 0xffff0000, v29
    v_lshlrev_b32 v112, 16, v30
    v_and_b32 v113, 0xffff0000, v30
    v_lshlrev_b32 v114, 16, v31
    v_and_b32 v115, 0xffff0000, v31
    v_add_f32 v100, v100, v108
    v_add_f32 v101, v101, v109
    v_add_f32 v102, v102, v110
    v_add_f32 v103, v103, v111
    v_add_f32 v104, v104, v112
    v_add_f32 v105, v105, v113
    v_add_f32 v106, v106, v114
    v_add_f32 v107, v107, v115
    v_cvt_pk_bf16_f32 v116, v100, v101
    v_cvt_pk_bf16_f32 v117, v102, v103
    v_cvt_pk_bf16_f32 v118, v104, v105
    v_cvt_pk_bf16_f32 v119, v106, v107
    s_nop 0
    v_permlane32_swap_b32 v116, v118
    v_permlane32_swap_b32 v117, v119
    s_nop 0
    v_permlane16_swap_b32 v116, v118
    v_permlane16_swap_b32 v117, v119
    buffer_store_dwordx4 v[116:119], v172, s[76:79], s70 offen
    s_waitcnt vmcnt(8)
    v_lshlrev_b32 v120, 16, v32
    v_and_b32 v121, 0xffff0000, v32
    v_lshlrev_b32 v122, 16, v33
    v_and_b32 v123, 0xffff0000, v33
    v_lshlrev_b32 v124, 16, v34
    v_and_b32 v125, 0xffff0000, v34
    v_lshlrev_b32 v126, 16, v35
    v_and_b32 v127, 0xffff0000, v35
    s_waitcnt vmcnt(7)
    v_lshlrev_b32 v128, 16, v36
    v_and_b32 v129, 0xffff0000, v36
    v_lshlrev_b32 v130, 16, v37
    v_and_b32 v131, 0xffff0000, v37
    v_lshlrev_b32 v132, 16, v38
    v_and_b32 v133, 0xffff0000, v38
    v_lshlrev_b32 v134, 16, v39
    v_and_b32 v135, 0xffff0000, v39
    v_add_f32 v120, v120, v128
    v_add_f32 v121, v121, v129
    v_add_f32 v122, v122, v130
    v_add_f32 v123, v123, v131
    v_add_f32 v124, v124, v132
    v_add_f32 v125, v125, v133
    v_add_f32 v126, v126, v134
    v_add_f32 v127, v127, v135
    s_waitcnt vmcnt(6)
    v_lshlrev_b32 v128, 16, v40
    v_and_b32 v129, 0xffff0000, v40
    v_lshlrev_b32 v130, 16, v41
    v_and_b32 v131, 0xffff0000, v41
    v_lshlrev_b32 v132, 16, v42
    v_and_b32 v133, 0xffff0000, v42
    v_lshlrev_b32 v134, 16, v43
    v_and_b32 v135, 0xffff0000, v43
    v_add_f32 v120, v120, v128
    v_add_f32 v121, v121, v129
    v_add_f32 v122, v122, v130
    v_add_f32 v123, v123, v131
    v_add_f32 v124, v124, v132
    v_add_f32 v125, v125, v133
    v_add_f32 v126, v126, v134
    v_add_f32 v127, v127, v135
    s_waitcnt vmcnt(5)
    v_lshlrev_b32 v128, 16, v44
    v_and_b32 v129, 0xffff0000, v44
    v_lshlrev_b32 v130, 16, v45
    v_and_b32 v131, 0xffff0000, v45
    v_lshlrev_b32 v132, 16, v46
    v_and_b32 v133, 0xffff0000, v46
    v_lshlrev_b32 v134, 16, v47
    v_and_b32 v135, 0xffff0000, v47
    v_add_f32 v120, v120, v128
    v_add_f32 v121, v121, v129
    v_add_f32 v122, v122, v130
    v_add_f32 v123, v123, v131
    v_add_f32 v124, v124, v132
    v_add_f32 v125, v125, v133
    v_add_f32 v126, v126, v134
    v_add_f32 v127, v127, v135
    s_waitcnt vmcnt(4)
    v_lshlrev_b32 v128, 16, v48
    v_and_b32 v129, 0xffff0000, v48
    v_lshlrev_b32 v130, 16, v49
    v_and_b32 v131, 0xffff0000, v49
    v_lshlrev_b32 v132, 16, v50
    v_and_b32 v133, 0xffff0000, v50
    v_lshlrev_b32 v134, 16, v51
    v_and_b32 v135, 0xffff0000, v51
    v_add_f32 v120, v120, v128
    v_add_f32 v121, v121, v129
    v_add_f32 v122, v122, v130
    v_add_f32 v123, v123, v131
    v_add_f32 v124, v124, v132
    v_add_f32 v125, v125, v133
    v_add_f32 v126, v126, v134
    v_add_f32 v127, v127, v135
    s_waitcnt vmcnt(3)
    v_lshlrev_b32 v128, 16, v52
    v_and_b32 v129, 0xffff0000, v52
    v_lshlrev_b32 v130, 16, v53
    v_and_b32 v131, 0xffff0000, v53
    v_lshlrev_b32 v132, 16, v54
    v_and_b32 v133, 0xffff0000, v54
    v_lshlrev_b32 v134, 16, v55
    v_and_b32 v135, 0xffff0000, v55
    v_add_f32 v120, v120, v128
    v_add_f32 v121, v121, v129
    v_add_f32 v122, v122, v130
    v_add_f32 v123, v123, v131
    v_add_f32 v124, v124, v132
    v_add_f32 v125, v125, v133
    v_add_f32 v126, v126, v134
    v_add_f32 v127, v127, v135
    s_waitcnt vmcnt(2)
    v_lshlrev_b32 v128, 16, v56
    v_and_b32 v129, 0xffff0000, v56
    v_lshlrev_b32 v130, 16, v57
    v_and_b32 v131, 0xffff0000, v57
    v_lshlrev_b32 v132, 16, v58
    v_and_b32 v133, 0xffff0000, v58
    v_lshlrev_b32 v134, 16, v59
    v_and_b32 v135, 0xffff0000, v59
    v_add_f32 v120, v120, v128
    v_add_f32 v121, v121, v129
    v_add_f32 v122, v122, v130
    v_add_f32 v123, v123, v131
    v_add_f32 v124, v124, v132
    v_add_f32 v125, v125, v133
    v_add_f32 v126, v126, v134
    v_add_f32 v127, v127, v135
    s_waitcnt vmcnt(1)
    v_lshlrev_b32 v128, 16, v60
    v_and_b32 v129, 0xffff0000, v60
    v_lshlrev_b32 v130, 16, v61
    v_and_b32 v131, 0xffff0000, v61
    v_lshlrev_b32 v132, 16, v62
    v_and_b32 v133, 0xffff0000, v62
    v_lshlrev_b32 v134, 16, v63
    v_and_b32 v135, 0xffff0000, v63
    v_add_f32 v120, v120, v128
    v_add_f32 v121, v121, v129
    v_add_f32 v122, v122, v130
    v_add_f32 v123, v123, v131
    v_add_f32 v124, v124, v132
    v_add_f32 v125, v125, v133
    v_add_f32 v126, v126, v134
    v_add_f32 v127, v127, v135
    v_cvt_pk_bf16_f32 v136, v120, v121
    v_cvt_pk_bf16_f32 v137, v122, v123
    v_cvt_pk_bf16_f32 v138, v124, v125
    v_cvt_pk_bf16_f32 v139, v126, v127
    s_nop 0
    v_permlane32_swap_b32 v136, v138
    v_permlane32_swap_b32 v137, v139
    s_nop 0
    v_permlane16_swap_b32 v136, v138
    v_permlane16_swap_b32 v137, v139
    buffer_store_dwordx4 v[136:139], v172, s[76:79], s71 offen
    s_endpgm
L_main_end:
    s_endpgm
L_text_end:
.section .rodata,"a"
.p2align 6
.amdhsa_kernel concat_heads__mha_block_cached__gqa_block_cached__near_ridge_kernel
  .amdhsa_next_free_vgpr 512
  .amdhsa_next_free_sgpr 102
  .amdhsa_accum_offset 256
  .amdhsa_group_segment_fixed_size 0
  .amdhsa_kernarg_size 104
  .amdhsa_user_sgpr_count 2
  .amdhsa_user_sgpr_kernarg_segment_ptr 1
  .amdhsa_system_sgpr_workgroup_id_x 1
  .amdhsa_float_denorm_mode_32 3
.end_amdhsa_kernel
```
